```python
import torch

def _softmax(x, axis=-1):
    return torch.softmax(x, dim=axis)
def _gelu(x):
    return torch.nn.functional.gelu(x, approximate="tanh")
def _silu(x):
    return torch.nn.functional.silu(x)
def _sigmoid(x):
    return torch.sigmoid(x)
def _layernorm(x, axis=-1, eps=1e-5):
    m = x.mean(dim=axis, keepdim=True)
    v = x.var(dim=axis, keepdim=True, unbiased=False)
    return (x - m) / torch.sqrt(v + eps)
def _scatter_add(tgt, idx, src, axis=0):
    return tgt.clone().index_add_(axis, idx, src)
def _segment_sum(src, seg, n):
    out = torch.zeros((n,) + src.shape[1:], dtype=src.dtype)
    return out.index_add_(0, seg, src)
def _pad(x, pw):
    flat = tuple(v for pair in reversed(pw) for v in pair)
    return torch.nn.functional.pad(x, flat)

kernel_name = 'standalone__cheap_equivariant_egnn__graph'

def setup_inputs():

    _w = (lambda a: (lambda t: t.to(torch.bfloat16) if t.is_floating_point() else t)(torch.as_tensor(a)))
    N, deg, D, De = 10000, 16, 128, max(16, 1)
    E = N * deg
    return {
        "h": _w((lambda *s: torch.randn(*s, dtype=torch.bfloat16) * 0.2)(N, D)),
        "pos": _w((lambda *s: torch.randn(*s, dtype=torch.bfloat16) * 0.8)(N, 3)),
        "e_attr": _w((lambda *s: torch.randn(*s, dtype=torch.bfloat16) * 0.8)(E, De)),
        "src": _w((lambda lo, hi, *s: torch.randint(lo, hi, s))(0, N, E).to(torch.int64)),
        "dst": _w((lambda lo, hi, *s: torch.randint(lo, hi, s))(0, N, E).to(torch.int64)),
        "w_e": _w(0.1 * (lambda *s: torch.randn(*s, dtype=torch.bfloat16) * 0.8)(2 * D + 1 + De, D)),
        "w_x": _w(0.1 * (lambda *s: torch.randn(*s, dtype=torch.bfloat16) * 0.2)(D, 1)),
        "w_h": _w(0.1 * (lambda *s: torch.randn(*s, dtype=torch.bfloat16) * 0.2)(2 * D, D)),
    }

def reference(h, pos, e_attr, src, dst, w_e, w_x, w_h):
    N, D = h.shape[0], h.shape[1]
    diff = pos[dst] - pos[src]
    dist2 = torch.sum(diff * diff, axis=-1, keepdims=True)
    e_in = torch.concatenate([h[dst], h[src], dist2, e_attr], axis=-1)
    m_ij = _silu(e_in @ w_e)
    coord_scale = m_ij @ w_x
    pos_new = pos + _segment_sum(diff * coord_scale, dst, N)
    m_i = _segment_sum(m_ij, dst, N)
    h_new = h + _silu(torch.concatenate([h, m_i], axis=-1) @ w_h)
    return h_new, pos_new
```

```asm
; @launch kernel=egnn_prep_kernel grid=(256,1,1) block=(1024,1,1) lds=106496
; @launch kernel=standalone__cheap_equivariant_egnn__graph_kernel grid=(250,1,1) block=(1024,1,1) lds=163840
.amdgcn_target "amdgcn-amd-amdhsa--gfx950"
.text
.globl egnn_prep_kernel
.p2align 8
.type egnn_prep_kernel,@function
egnn_prep_kernel:
    s_cmp_ge_u32 s2, 256
    s_cbranch_scc1 K1_end
    s_cmp_ge_u32 s2, 64
    s_cbranch_scc1 K1_q
    s_load_dwordx4 s[8:11], s[0:1], 24
    s_load_dwordx2 s[18:19], s[0:1], 80
    s_load_dwordx2 s[4:5], s[0:1], 8
    s_load_dwordx2 s[48:49], s[0:1], 0
    s_load_dwordx2 s[50:51], s[0:1], 40
    v_lshlrev_b32 v1, 4, v0
    s_mul_i32 s3, s2, 10000
    v_cmp_gt_u32 vcc, 625, v0
    v_mov_b32 v12, -1
    v_mov_b32 v13, -1
    v_mov_b32 v14, -1
    v_mov_b32 v15, -1
    v_lshlrev_b32 v2, 2, v0
    v_mov_b32 v3, 0
    s_waitcnt lgkmcnt(0)
    s_mov_b32 s24, s10
    s_mov_b32 s25, s11
    s_mov_b32 s26, 640000
    s_mov_b32 s27, 0x20000
    s_mov_b32 s20, s8
    s_mov_b32 s21, s9
    s_mov_b32 s22, 640000
    s_mov_b32 s23, 0x20000
    s_and_saveexec_b64 s[32:33], vcc
    s_cbranch_execz K1_b1
    buffer_load_dwordx4 v[4:7], v1, s[24:27], s3 offen
    buffer_load_dwordx4 v[8:11], v1, s[20:23], s3 offen
K1_b1:
    s_mov_b64 exec, s[32:33]
    v_lshrrev_b32 v40, 6, v0
    s_nop 0
    v_readfirstlane_b32 s38, v40
    s_nop 0
    s_sub_u32 s39, s38, 10
    s_cmp_ge_u32 s39, 2
    s_cbranch_scc1 K1_np4
    s_mov_b32 s40, s4
    s_mov_b32 s41, s5
    s_mov_b32 s42, 60000
    s_mov_b32 s43, 0x20000
    s_lshl_b32 s44, s2, 1
    s_add_u32 s44, s44, s39
    s_lshl_b32 s44, s44, 6
    v_and_b32 v40, 63, v0
    v_add_u32 v40, s44, v40
    v_mul_u32_u24 v41, 12, v40
    buffer_load_dwordx3 v[44:46], v41, s[40:43], 0 offen
K1_np4:
    s_mul_i32 s54, s2, 24576
    v_lshrrev_b32 v60, 6, v0
    v_and_b32 v61, 63, v0
    v_readfirstlane_b32 s52, v60
    v_lshrrev_b32 v62, 4, v61
    v_xor_b32 v64, v62, v61
    v_and_b32 v64, 15, v64
    v_lshlrev_b32 v63, 8, v62
    v_lshl_add_u32 v63, v64, 4, v63
    v_lshlrev_b32 v64, 2, v62
    v_xor_b32 v64, v64, v61
    v_and_b32 v64, 15, v64
    v_lshlrev_b32 v65, 8, v62
    v_lshl_add_u32 v65, v64, 4, v65
    s_and_b32 s76, s52, 3
    s_lshr_b32 s77, s52, 2
    v_and_b32 v70, 31, v61
    v_lshrrev_b32 v71, 5, v61
    v_and_b32 v66, 15, v70
    v_xor_b32 v66, v66, v71
    v_lshlrev_b32 v66, 4, v66
    v_lshl_add_u32 v66, v70, 8, v66
    s_lshl_b32 s78, s77, 13
    s_add_u32 s78, s78, 67584
    v_add_u32 v66, s78, v66
    v_bfe_u32 v67, v61, 2, 2
    v_bfe_u32 v72, v61, 4, 1
    v_bfe_u32 v73, v61, 1, 1
    v_lshl_add_u32 v72, v72, 1, v73
    s_lshl_b32 s79, s76, 2
    v_add_u32 v72, s79, v72
    v_lshlrev_b32 v73, 2, v67
    v_xor_b32 v72, v72, v73
    v_lshl_add_u32 v67, v71, 3, v67
    v_lshlrev_b32 v67, 8, v67
    v_lshl_add_u32 v67, v72, 4, v67
    v_and_b32 v72, 1, v61
    v_lshl_add_u32 v67, v72, 3, v67
    v_add_u32 v67, 34816, v67
    v_lshlrev_b32 v68, 4, v70
    v_lshl_add_u32 v68, v71, 11, v68
    s_lshl_b32 s78, s76, 9
    v_add_u32 v68, s78, v68
    s_lshr_b32 s58, s54, 11
    s_lshl_b32 s59, s77, 2
    s_add_u32 s58, s58, s59
    s_lshl_b32 s58, s58, 11
    s_mov_b32 s59, s77
    ds_write_b128 v1, v[12:15]
    ds_write_b128 v1, v[12:15] offset:16384
    v_cmp_gt_u32 vcc, 256, v0
    s_nop 0
    s_and_saveexec_b64 s[34:35], vcc
    s_cbranch_execz K1_b2
    ds_write_b32 v2, v3 offset:32768
K1_b2:
    s_mov_b64 exec, s[34:35]
    s_mov_b32 s28, s18
    s_mov_b32 s29, s19
    s_mov_b32 s30, 2048000
    s_mov_b32 s31, 0x20000
    v_lshlrev_b32 v16, 22, v0
    v_mov_b32 v17, 1
    v_mov_b32 v36, 33788
    s_waitcnt lgkmcnt(0)
    s_barrier
    s_cmp_lt_u32 s52, 10
    s_cbranch_scc1 K1_rank
    s_mov_b32 s72, s48
    s_mov_b32 s73, s49
    s_mov_b32 s74, 2560000
    s_mov_b32 s75, 0x20000
    s_mov_b32 s44, s50
    s_mov_b32 s45, s51
    s_mov_b32 s46, 69888
    s_mov_b32 s47, 0x20000
    s_sub_u32 s53, s52, 10
K1_st6:
    s_cmp_ge_u32 s53, 24
    s_cbranch_scc1 K1_st6w
    s_and_b32 s55, s53, 3
    s_lshl_b32 s55, s55, 6
    v_xor_b32 v64, s55, v63
    s_lshl_b32 s55, s53, 10
    s_add_u32 m0, s55, 67584
    s_add_u32 s55, s55, s54
    buffer_load_dwordx4 v64, s[72:75], s55 offen lds
    s_branch K1_st6n
K1_st6w:
    s_sub_u32 s55, s53, 24
    s_lshl_b32 s55, s55, 10
    s_add_u32 m0, s55, 34816
    s_nop 0
    buffer_load_dwordx4 v65, s[44:47], s55 offen lds
K1_st6n:
    s_add_u32 s53, s53, 6
    s_cmp_lt_u32 s53, 56
    s_cbranch_scc1 K1_st6
    s_branch K1_b3x
K1_rank:
    v_cmp_gt_u32 vcc, 625, v0
    s_nop 0
    s_and_saveexec_b64 s[32:33], vcc
    s_cbranch_execz K1_b3
    s_waitcnt vmcnt(0)
    v_mul_u32_u24 v20, 52429, v4
    v_lshrrev_b32 v20, 21, v20
    v_lshlrev_b32 v28, 2, v20
    ds_add_rtn_u32 v24, v28, v17 offset:32768
    v_mul_u32_u24 v21, 52429, v5
    v_lshrrev_b32 v21, 21, v21
    v_lshlrev_b32 v29, 2, v21
    ds_add_rtn_u32 v25, v29, v17 offset:32768
    v_mul_u32_u24 v22, 52429, v6
    v_lshrrev_b32 v22, 21, v22
    v_lshlrev_b32 v30, 2, v22
    ds_add_rtn_u32 v26, v30, v17 offset:32768
    v_mul_u32_u24 v23, 52429, v7
    v_lshrrev_b32 v23, 21, v23
    v_lshlrev_b32 v31, 2, v23
    ds_add_rtn_u32 v27, v31, v17 offset:32768
    v_mul_u32_u24 v32, 40, v20
    v_sub_u32 v32, v4, v32
    v_lshl_or_b32 v8, v32, 14, v8
    v_or_b32 v8, v8, v16
    v_lshlrev_b32 v20, 7, v20
    v_mul_u32_u24 v33, 40, v21
    v_sub_u32 v33, v5, v33
    v_lshl_or_b32 v9, v33, 14, v9
    v_add_u32 v33, 1048576, v16
    v_or_b32 v9, v9, v33
    v_lshlrev_b32 v21, 7, v21
    v_mul_u32_u24 v34, 40, v22
    v_sub_u32 v34, v6, v34
    v_lshl_or_b32 v10, v34, 14, v10
    v_add_u32 v34, 2097152, v16
    v_or_b32 v10, v10, v34
    v_lshlrev_b32 v22, 7, v22
    v_mul_u32_u24 v35, 40, v23
    v_sub_u32 v35, v7, v35
    v_lshl_or_b32 v11, v35, 14, v11
    v_add_u32 v35, 3145728, v16
    v_or_b32 v11, v11, v35
    v_lshlrev_b32 v23, 7, v23
    s_waitcnt lgkmcnt(0)
    v_lshl_add_u32 v20, v24, 2, v20
    v_cmp_gt_u32 vcc, 32, v24
    s_nop 1
    v_cndmask_b32 v20, v36, v20, vcc
    ds_write_b32 v20, v8
    v_lshl_add_u32 v21, v25, 2, v21
    v_cmp_gt_u32 vcc, 32, v25
    s_nop 1
    v_cndmask_b32 v21, v36, v21, vcc
    ds_write_b32 v21, v9
    v_lshl_add_u32 v22, v26, 2, v22
    v_cmp_gt_u32 vcc, 32, v26
    s_nop 1
    v_cndmask_b32 v22, v36, v22, vcc
    ds_write_b32 v22, v10
    v_lshl_add_u32 v23, v27, 2, v23
    v_cmp_gt_u32 vcc, 32, v27
    s_nop 1
    v_cndmask_b32 v23, v36, v23, vcc
    ds_write_b32 v23, v11
K1_b3:
    s_mov_b64 exec, s[32:33]
K1_b3x:
    s_lshl_b32 s3, s2, 7
    v_lshrrev_b32 v2, 3, v0
    v_and_b32 v3, 7, v0
    v_lshlrev_b32 v4, 2, v2
    v_lshlrev_b32 v7, 13, v2
    v_lshl_add_u32 v7, v3, 4, v7
    v_add_u32 v16, 1048576, v7
    v_cmp_eq_u32 s[36:37], 7, v3
    v_mov_b32 v17, -2
    s_waitcnt lgkmcnt(0)
    s_barrier
    ds_read_b128 v[8:11], v1
    ds_read_b128 v[12:15], v1 offset:16384
    ds_read_b32 v5, v4 offset:32768
    ds_read_b32 v6, v4 offset:33280
    s_waitcnt lgkmcnt(0)
    v_cmp_lt_u32 vcc, 32, v5
    s_nop 0
    s_and_b64 vcc, vcc, s[36:37]
    v_cndmask_b32 v11, v11, v17, vcc
    v_cmp_lt_u32 vcc, 32, v6
    s_nop 0
    s_and_b64 vcc, vcc, s[36:37]
    v_cndmask_b32 v15, v15, v17, vcc
    buffer_store_dwordx4 v[8:11], v7, s[28:31], s3 offen sc0 sc1
    buffer_store_dwordx4 v[12:15], v16, s[28:31], s3 offen sc0 sc1
    s_cmp_ge_u32 s39, 2
    s_cbranch_scc1 K1_np4b
    s_add_u32 s40, s18, 10616832
    s_addc_u32 s41, s19, 0
    s_mov_b32 s42, 80000
    s_mov_b32 s43, 0x20000
    s_waitcnt vmcnt(2)
    v_mov_b32 v48, v44
    v_and_b32 v49, 0xffff, v45
    v_alignbit_b32 v50, v46, v45, 16
    v_lshrrev_b32 v51, 16, v46
    v_lshlrev_b32 v41, 4, v40
    buffer_store_dwordx4 v[48:51], v41, s[40:43], 0 offen sc0 sc1
K1_np4b:
    s_add_u32 s44, s18, 4718592
    s_addc_u32 s45, s19, 0
    s_mov_b32 s46, 2560000
    s_mov_b32 s47, 0x20000
    v_mov_b32 v2, v68
    v_mov_b32 v6, v66
    v_mov_b32 v9, v67
    s_mov_b32 s40, 0x3fb8aa3b
    s_waitcnt vmcnt(2)
    s_barrier
    s_cmp_ge_u32 s59, 3
    s_cbranch_scc1 K1_pend
    ds_read_b64_tr_b16 v[48:49], v9 offset:0
    ds_read_b64_tr_b16 v[50:51], v9 offset:1024
    ds_read_b64_tr_b16 v[52:53], v9 offset:4096
    ds_read_b64_tr_b16 v[54:55], v9 offset:5120
    ds_read_b64_tr_b16 v[56:57], v9 offset:8192
    ds_read_b64_tr_b16 v[58:59], v9 offset:9216
    ds_read_b64_tr_b16 v[60:61], v9 offset:12288
    ds_read_b64_tr_b16 v[62:63], v9 offset:13312
    ds_read_b64_tr_b16 v[64:65], v9 offset:16384
    ds_read_b64_tr_b16 v[66:67], v9 offset:17408
    ds_read_b64_tr_b16 v[68:69], v9 offset:20480
    ds_read_b64_tr_b16 v[70:71], v9 offset:21504
    ds_read_b64_tr_b16 v[72:73], v9 offset:24576
    ds_read_b64_tr_b16 v[74:75], v9 offset:25600
    ds_read_b64_tr_b16 v[76:77], v9 offset:28672
    ds_read_b64_tr_b16 v[78:79], v9 offset:29696
    v_mov_b32 v7, v6
    ds_read_b128 v[16:19], v7
    v_xor_b32 v7, 32, v6
    ds_read_b128 v[20:23], v7
    v_xor_b32 v7, 64, v6
    ds_read_b128 v[24:27], v7
    v_xor_b32 v7, 96, v6
    ds_read_b128 v[28:31], v7
    v_xor_b32 v7, 128, v6
    ds_read_b128 v[32:35], v7
    v_xor_b32 v7, 160, v6
    ds_read_b128 v[36:39], v7
    v_xor_b32 v7, 192, v6
    ds_read_b128 v[40:43], v7
    v_xor_b32 v7, 224, v6
    ds_read_b128 v[44:47], v7
    s_waitcnt lgkmcnt(0)
    v_mfma_f32_32x32x16_bf16 v[80:95], v[16:19], v[48:51], 0
    v_mfma_f32_32x32x16_bf16 v[80:95], v[20:23], v[52:55], v[80:95]
    v_mfma_f32_32x32x16_bf16 v[80:95], v[24:27], v[56:59], v[80:95]
    v_mfma_f32_32x32x16_bf16 v[80:95], v[28:31], v[60:63], v[80:95]
    v_mfma_f32_32x32x16_bf16 v[80:95], v[32:35], v[64:67], v[80:95]
    v_mfma_f32_32x32x16_bf16 v[80:95], v[36:39], v[68:71], v[80:95]
    v_mfma_f32_32x32x16_bf16 v[80:95], v[40:43], v[72:75], v[80:95]
    v_mfma_f32_32x32x16_bf16 v[80:95], v[44:47], v[76:79], v[80:95]
    v_mov_b32 v15, s40
    s_nop 10
    v_mul_f32 v80, v15, v80
    v_mul_f32 v81, v15, v81
    v_mul_f32 v82, v15, v82
    v_mul_f32 v83, v15, v83
    v_mul_f32 v84, v15, v84
    v_mul_f32 v85, v15, v85
    v_mul_f32 v86, v15, v86
    v_mul_f32 v87, v15, v87
    v_mul_f32 v88, v15, v88
    v_mul_f32 v89, v15, v89
    v_mul_f32 v90, v15, v90
    v_mul_f32 v91, v15, v91
    v_mul_f32 v92, v15, v92
    v_mul_f32 v93, v15, v93
    v_mul_f32 v94, v15, v94
    v_mul_f32 v95, v15, v95
    v_cvt_pk_bf16_f32 v96, v80, v81
    v_cvt_pk_bf16_f32 v97, v82, v83
    v_cvt_pk_bf16_f32 v98, v84, v85
    v_cvt_pk_bf16_f32 v99, v86, v87
    v_cvt_pk_bf16_f32 v100, v88, v89
    v_cvt_pk_bf16_f32 v101, v90, v91
    v_cvt_pk_bf16_f32 v102, v92, v93
    v_cvt_pk_bf16_f32 v103, v94, v95
    v_permlane32_swap_b32 v96, v98
    v_permlane32_swap_b32 v97, v99
    v_permlane32_swap_b32 v100, v102
    v_permlane32_swap_b32 v101, v103
    s_add_u32 s43, s58, 0
    buffer_store_dwordx4 v[96:99], v2, s[44:47], s43 offen sc0 sc1
    s_add_u32 s43, s58, 4096
    buffer_store_dwordx4 v[100:103], v2, s[44:47], s43 offen sc0 sc1
K1_pend:
    s_endpgm
K1_q:
    s_cmp_ge_u32 s2, 253
    s_cbranch_scc1 K1_img
    s_cmp_ge_u32 s2, 222
    s_cbranch_scc1 K1_ponly
    s_load_dwordx2 s[4:5], s[0:1], 0
    s_load_dwordx2 s[12:13], s[0:1], 40
    s_load_dwordx2 s[16:17], s[0:1], 56
    s_load_dwordx2 s[18:19], s[0:1], 80
    v_lshrrev_b32 v1, 6, v0
    v_and_b32 v2, 63, v0
    v_readfirstlane_b32 s3, v1
    s_cmp_ge_u32 s2, 143
    s_cselect_b32 s41, 1, 0
    s_cselect_b32 s33, 143, 64
    s_sub_u32 s2, s2, s33
    v_lshrrev_b32 v4, 4, v2
    s_lshl_b32 s33, s3, 2
    v_add_u32 v5, s33, v4
    v_xor_b32 v6, v5, v2
    v_and_b32 v6, 15, v6
    v_lshlrev_b32 v5, 8, v5
    v_lshl_add_u32 v5, v6, 4, v5
    v_lshlrev_b32 v6, 2, v4
    v_xor_b32 v6, v6, v2
    v_and_b32 v6, 15, v6
    v_lshlrev_b32 v3, 8, v4
    v_lshl_add_u32 v3, v6, 4, v3
    s_lshl_b32 s34, s2, 15
    s_lshl_b32 s35, s3, 10
    s_lshl_b32 s36, s3, 11
    s_waitcnt lgkmcnt(0)
    s_mov_b32 s24, s4
    s_mov_b32 s25, s5
    s_mov_b32 s26, 2560000
    s_mov_b32 s27, 0x20000
    s_add_u32 m0, s35, 32768
    s_add_u32 s37, s34, 0
    buffer_load_dwordx4 v5, s[24:27], s37 offen lds
    s_add_u32 m0, s35, 49152
    s_add_u32 s37, s34, 16384
    buffer_load_dwordx4 v5, s[24:27], s37 offen lds
    s_cmp_eq_u32 s41, 1
    s_cbranch_scc1 K1_rw
    s_mov_b32 s20, s12
    s_mov_b32 s21, s13
    s_mov_b32 s22, 69888
    s_mov_b32 s23, 0x20000
    s_mov_b32 s38, 32768
    s_mov_b32 s40, 0x3fb8aa3b
    s_add_u32 s28, s18, 2097152
    s_addc_u32 s29, s19, 0
    s_mov_b32 s30, 2560256
    s_mov_b32 s31, 0x20000
    s_add_u32 s45, s34, 256
    s_branch K1_wgo
K1_rw:
    s_mov_b32 s20, s16
    s_mov_b32 s21, s17
    s_mov_b32 s22, 65536
    s_mov_b32 s23, 0x20000
    s_mov_b32 s38, 0
    s_mov_b32 s40, 0x3fb8aa3b
    s_add_u32 s28, s18, 7340032
    s_addc_u32 s29, s19, 0
    s_mov_b32 s30, 2560000
    s_mov_b32 s31, 0x20000
    s_mov_b32 s45, s34
K1_wgo:
    s_add_u32 s37, s36, 0
    s_add_u32 m0, s37, 0
    s_add_u32 s37, s37, s38
    buffer_load_dwordx4 v3, s[20:23], s37 offen lds
    s_add_u32 s37, s36, 1024
    s_add_u32 m0, s37, 0
    s_add_u32 s37, s37, s38
    buffer_load_dwordx4 v3, s[20:23], s37 offen lds
    s_and_b32 s35, s3, 3
    s_lshr_b32 s36, s3, 2
    v_and_b32 v4, 31, v2
    v_lshrrev_b32 v5, 5, v2
    v_and_b32 v6, 15, v4
    v_xor_b32 v6, v6, v5
    v_lshlrev_b32 v6, 4, v6
    v_lshl_add_u32 v6, v4, 8, v6
    s_lshl_b32 s37, s36, 13
    s_add_u32 s37, s37, 32768
    v_add_u32 v6, s37, v6
    v_bfe_u32 v9, v2, 2, 2
    v_bfe_u32 v10, v2, 4, 1
    v_bfe_u32 v11, v2, 1, 1
    v_lshl_add_u32 v10, v10, 1, v11
    s_lshl_b32 s39, s35, 2
    v_add_u32 v10, s39, v10
    v_lshlrev_b32 v11, 2, v9
    v_xor_b32 v10, v10, v11
    v_lshl_add_u32 v9, v5, 3, v9
    v_lshlrev_b32 v9, 8, v9
    v_lshl_add_u32 v9, v10, 4, v9
    v_and_b32 v10, 1, v2
    v_lshl_add_u32 v9, v10, 3, v9
    s_lshl_b32 s39, s35, 6
    s_mul_i32 s37, s3, 2560
    s_add_u32 s37, s37, 65536
    v_mul_u32_u24 v12, 80, v4
    v_lshl_add_u32 v12, v5, 3, v12
    v_add_u32 v12, s37, v12
    v_lshrrev_b32 v13, 2, v2
    v_and_b32 v14, 3, v2
    v_lshlrev_b32 v15, 8, v13
    v_lshl_add_u32 v15, v14, 4, v15
    v_mul_u32_u24 v13, 80, v13
    v_lshl_add_u32 v13, v14, 4, v13
    v_add_u32 v13, s37, v13
    s_lshl_b32 s37, s36, 13
    s_add_u32 s45, s45, s37
    s_add_u32 s45, s45, s39
    v_mov_b32 v14, v15
    s_waitcnt vmcnt(0)
    s_barrier
    ds_read_b64_tr_b16 v[48:49], v9 offset:0
    ds_read_b64_tr_b16 v[50:51], v9 offset:1024
    ds_read_b64_tr_b16 v[52:53], v9 offset:4096
    ds_read_b64_tr_b16 v[54:55], v9 offset:5120
    ds_read_b64_tr_b16 v[56:57], v9 offset:8192
    ds_read_b64_tr_b16 v[58:59], v9 offset:9216
    ds_read_b64_tr_b16 v[60:61], v9 offset:12288
    ds_read_b64_tr_b16 v[62:63], v9 offset:13312
    ds_read_b64_tr_b16 v[64:65], v9 offset:16384
    ds_read_b64_tr_b16 v[66:67], v9 offset:17408
    ds_read_b64_tr_b16 v[68:69], v9 offset:20480
    ds_read_b64_tr_b16 v[70:71], v9 offset:21504
    ds_read_b64_tr_b16 v[72:73], v9 offset:24576
    ds_read_b64_tr_b16 v[74:75], v9 offset:25600
    ds_read_b64_tr_b16 v[76:77], v9 offset:28672
    ds_read_b64_tr_b16 v[78:79], v9 offset:29696
    v_mov_b32 v7, v6
    ds_read_b128 v[16:19], v7
    v_xor_b32 v7, 32, v6
    ds_read_b128 v[20:23], v7
    v_xor_b32 v7, 64, v6
    ds_read_b128 v[24:27], v7
    v_xor_b32 v7, 96, v6
    ds_read_b128 v[28:31], v7
    v_xor_b32 v7, 128, v6
    ds_read_b128 v[32:35], v7
    v_xor_b32 v7, 160, v6
    ds_read_b128 v[36:39], v7
    v_xor_b32 v7, 192, v6
    ds_read_b128 v[40:43], v7
    v_xor_b32 v7, 224, v6
    ds_read_b128 v[44:47], v7
    s_waitcnt lgkmcnt(0)
    v_mfma_f32_32x32x16_bf16 v[80:95], v[48:51], v[16:19], 0
    v_mfma_f32_32x32x16_bf16 v[80:95], v[52:55], v[20:23], v[80:95]
    v_mfma_f32_32x32x16_bf16 v[80:95], v[56:59], v[24:27], v[80:95]
    v_mfma_f32_32x32x16_bf16 v[80:95], v[60:63], v[28:31], v[80:95]
    v_mfma_f32_32x32x16_bf16 v[80:95], v[64:67], v[32:35], v[80:95]
    v_mfma_f32_32x32x16_bf16 v[80:95], v[68:71], v[36:39], v[80:95]
    v_mfma_f32_32x32x16_bf16 v[80:95], v[72:75], v[40:43], v[80:95]
    v_mfma_f32_32x32x16_bf16 v[80:95], v[76:79], v[44:47], v[80:95]
    v_mov_b32 v15, s40
    s_nop 10
    v_mul_f32 v80, v15, v80
    v_mul_f32 v81, v15, v81
    v_mul_f32 v82, v15, v82
    v_mul_f32 v83, v15, v83
    v_mul_f32 v84, v15, v84
    v_mul_f32 v85, v15, v85
    v_mul_f32 v86, v15, v86
    v_mul_f32 v87, v15, v87
    v_mul_f32 v88, v15, v88
    v_mul_f32 v89, v15, v89
    v_mul_f32 v90, v15, v90
    v_mul_f32 v91, v15, v91
    v_mul_f32 v92, v15, v92
    v_mul_f32 v93, v15, v93
    v_mul_f32 v94, v15, v94
    v_mul_f32 v95, v15, v95
    v_cvt_pk_bf16_f32 v96, v80, v81
    v_cvt_pk_bf16_f32 v97, v82, v83
    v_cvt_pk_bf16_f32 v98, v84, v85
    v_cvt_pk_bf16_f32 v99, v86, v87
    v_cvt_pk_bf16_f32 v100, v88, v89
    v_cvt_pk_bf16_f32 v101, v90, v91
    v_cvt_pk_bf16_f32 v102, v92, v93
    v_cvt_pk_bf16_f32 v103, v94, v95
    ds_write_b64 v12, v[96:97] offset:0
    ds_write_b64 v12, v[98:99] offset:16
    ds_write_b64 v12, v[100:101] offset:32
    ds_write_b64 v12, v[102:103] offset:48
    s_add_u32 s36, s45, 4096
    s_waitcnt lgkmcnt(0)
    ds_read_b128 v[16:19], v13
    ds_read_b128 v[20:23], v13 offset:1280
    s_waitcnt lgkmcnt(1)
    buffer_store_dwordx4 v[16:19], v14, s[28:31], s45 offen sc0 sc1
    s_waitcnt lgkmcnt(0)
    buffer_store_dwordx4 v[20:23], v14, s[28:31], s36 offen sc0 sc1
    s_or_b32 s36, s41, s2
    s_cmp_lg_u32 s36, 0
    s_cbranch_scc1 K1_gend
    v_cmp_gt_u32 vcc, 16, v0
    s_nop 0
    s_and_saveexec_b64 s[32:33], vcc
    s_cbranch_execz K1_gend
    v_mov_b32 v28, 0
    v_mov_b32 v29, 0
    v_mov_b32 v30, 0
    v_mov_b32 v31, 0
    v_lshlrev_b32 v14, 4, v0
    buffer_store_dwordx4 v[28:31], v14, s[28:31], 0 offen sc0 sc1
K1_gend:
    s_mov_b64 exec, -1
    s_endpgm
K1_ponly:
    s_load_dwordx2 s[18:19], s[0:1], 80
    s_load_dwordx2 s[48:49], s[0:1], 0
    s_load_dwordx2 s[50:51], s[0:1], 40
    s_sub_u32 s2, s2, 222
    s_lshl_b32 s54, s2, 15
    s_add_u32 s54, s54, 1572864
    s_waitcnt lgkmcnt(0)
    v_lshrrev_b32 v60, 6, v0
    v_and_b32 v61, 63, v0
    v_readfirstlane_b32 s52, v60
    v_lshrrev_b32 v62, 4, v61
    s_lshl_b32 s53, s52, 2
    v_add_u32 v63, s53, v62
    v_xor_b32 v64, v63, v61
    v_and_b32 v64, 15, v64
    v_lshlrev_b32 v63, 8, v63
    v_lshl_add_u32 v63, v64, 4, v63
    v_lshlrev_b32 v64, 2, v62
    v_xor_b32 v64, v64, v61
    v_and_b32 v64, 15, v64
    v_lshlrev_b32 v65, 8, v62
    v_lshl_add_u32 v65, v64, 4, v65
    s_mov_b32 s72, s48
    s_mov_b32 s73, s49
    s_mov_b32 s74, 2560000
    s_mov_b32 s75, 0x20000
    s_mov_b32 s44, s50
    s_mov_b32 s45, s51
    s_mov_b32 s46, 69888
    s_mov_b32 s47, 0x20000
    s_lshl_b32 s55, s52, 10
    s_add_u32 m0, s55, 67584
    s_add_u32 s53, s54, 0
    buffer_load_dwordx4 v63, s[72:75], s53 offen lds
    s_add_u32 m0, s55, 83968
    s_add_u32 s53, s54, 16384
    buffer_load_dwordx4 v63, s[72:75], s53 offen lds
    s_lshl_b32 s55, s52, 11
    s_add_u32 s53, s55, 0
    s_add_u32 m0, s53, 34816
    s_nop 0
    buffer_load_dwordx4 v65, s[44:47], s53 offen lds
    s_add_u32 s53, s55, 1024
    s_add_u32 m0, s53, 34816
    s_nop 0
    buffer_load_dwordx4 v65, s[44:47], s53 offen lds
    s_and_b32 s76, s52, 3
    s_lshr_b32 s77, s52, 2
    v_and_b32 v70, 31, v61
    v_lshrrev_b32 v71, 5, v61
    v_and_b32 v66, 15, v70
    v_xor_b32 v66, v66, v71
    v_lshlrev_b32 v66, 4, v66
    v_lshl_add_u32 v66, v70, 8, v66
    s_lshl_b32 s78, s77, 13
    s_add_u32 s78, s78, 67584
    v_add_u32 v66, s78, v66
    v_bfe_u32 v67, v61, 2, 2
    v_bfe_u32 v72, v61, 4, 1
    v_bfe_u32 v73, v61, 1, 1
    v_lshl_add_u32 v72, v72, 1, v73
    s_lshl_b32 s79, s76, 2
    v_add_u32 v72, s79, v72
    v_lshlrev_b32 v73, 2, v67
    v_xor_b32 v72, v72, v73
    v_lshl_add_u32 v67, v71, 3, v67
    v_lshlrev_b32 v67, 8, v67
    v_lshl_add_u32 v67, v72, 4, v67
    v_and_b32 v72, 1, v61
    v_lshl_add_u32 v67, v72, 3, v67
    v_add_u32 v67, 34816, v67
    v_lshlrev_b32 v68, 4, v70
    v_lshl_add_u32 v68, v71, 11, v68
    s_lshl_b32 s78, s76, 9
    v_add_u32 v68, s78, v68
    s_lshr_b32 s58, s54, 11
    s_lshl_b32 s59, s77, 2
    s_add_u32 s58, s58, s59
    s_lshl_b32 s58, s58, 11
    s_mov_b32 s59, s77
    s_add_u32 s44, s18, 4718592
    s_addc_u32 s45, s19, 0
    s_mov_b32 s46, 2560000
    s_mov_b32 s47, 0x20000
    v_mov_b32 v2, v68
    v_mov_b32 v6, v66
    v_mov_b32 v9, v67
    s_mov_b32 s40, 0x3fb8aa3b
    s_waitcnt vmcnt(0)
    s_barrier
    ds_read_b64_tr_b16 v[48:49], v9 offset:0
    ds_read_b64_tr_b16 v[50:51], v9 offset:1024
    ds_read_b64_tr_b16 v[52:53], v9 offset:4096
    ds_read_b64_tr_b16 v[54:55], v9 offset:5120
    ds_read_b64_tr_b16 v[56:57], v9 offset:8192
    ds_read_b64_tr_b16 v[58:59], v9 offset:9216
    ds_read_b64_tr_b16 v[60:61], v9 offset:12288
    ds_read_b64_tr_b16 v[62:63], v9 offset:13312
    ds_read_b64_tr_b16 v[64:65], v9 offset:16384
    ds_read_b64_tr_b16 v[66:67], v9 offset:17408
    ds_read_b64_tr_b16 v[68:69], v9 offset:20480
    ds_read_b64_tr_b16 v[70:71], v9 offset:21504
    ds_read_b64_tr_b16 v[72:73], v9 offset:24576
    ds_read_b64_tr_b16 v[74:75], v9 offset:25600
    ds_read_b64_tr_b16 v[76:77], v9 offset:28672
    ds_read_b64_tr_b16 v[78:79], v9 offset:29696
    v_mov_b32 v7, v6
    ds_read_b128 v[16:19], v7
    v_xor_b32 v7, 32, v6
    ds_read_b128 v[20:23], v7
    v_xor_b32 v7, 64, v6
    ds_read_b128 v[24:27], v7
    v_xor_b32 v7, 96, v6
    ds_read_b128 v[28:31], v7
    v_xor_b32 v7, 128, v6
    ds_read_b128 v[32:35], v7
    v_xor_b32 v7, 160, v6
    ds_read_b128 v[36:39], v7
    v_xor_b32 v7, 192, v6
    ds_read_b128 v[40:43], v7
    v_xor_b32 v7, 224, v6
    ds_read_b128 v[44:47], v7
    s_waitcnt lgkmcnt(0)
    v_mfma_f32_32x32x16_bf16 v[80:95], v[16:19], v[48:51], 0
    v_mfma_f32_32x32x16_bf16 v[80:95], v[20:23], v[52:55], v[80:95]
    v_mfma_f32_32x32x16_bf16 v[80:95], v[24:27], v[56:59], v[80:95]
    v_mfma_f32_32x32x16_bf16 v[80:95], v[28:31], v[60:63], v[80:95]
    v_mfma_f32_32x32x16_bf16 v[80:95], v[32:35], v[64:67], v[80:95]
    v_mfma_f32_32x32x16_bf16 v[80:95], v[36:39], v[68:71], v[80:95]
    v_mfma_f32_32x32x16_bf16 v[80:95], v[40:43], v[72:75], v[80:95]
    v_mfma_f32_32x32x16_bf16 v[80:95], v[44:47], v[76:79], v[80:95]
    v_mov_b32 v15, s40
    s_nop 10
    v_mul_f32 v80, v15, v80
    v_mul_f32 v81, v15, v81
    v_mul_f32 v82, v15, v82
    v_mul_f32 v83, v15, v83
    v_mul_f32 v84, v15, v84
    v_mul_f32 v85, v15, v85
    v_mul_f32 v86, v15, v86
    v_mul_f32 v87, v15, v87
    v_mul_f32 v88, v15, v88
    v_mul_f32 v89, v15, v89
    v_mul_f32 v90, v15, v90
    v_mul_f32 v91, v15, v91
    v_mul_f32 v92, v15, v92
    v_mul_f32 v93, v15, v93
    v_mul_f32 v94, v15, v94
    v_mul_f32 v95, v15, v95
    v_cvt_pk_bf16_f32 v96, v80, v81
    v_cvt_pk_bf16_f32 v97, v82, v83
    v_cvt_pk_bf16_f32 v98, v84, v85
    v_cvt_pk_bf16_f32 v99, v86, v87
    v_cvt_pk_bf16_f32 v100, v88, v89
    v_cvt_pk_bf16_f32 v101, v90, v91
    v_cvt_pk_bf16_f32 v102, v92, v93
    v_cvt_pk_bf16_f32 v103, v94, v95
    v_permlane32_swap_b32 v96, v98
    v_permlane32_swap_b32 v97, v99
    v_permlane32_swap_b32 v100, v102
    v_permlane32_swap_b32 v101, v103
    s_add_u32 s43, s58, 0
    buffer_store_dwordx4 v[96:99], v2, s[44:47], s43 offen sc0 sc1
    s_add_u32 s43, s58, 4096
    buffer_store_dwordx4 v[100:103], v2, s[44:47], s43 offen sc0 sc1
    s_endpgm
K1_img:
    s_load_dwordx4 s[12:15], s[0:1], 40
    s_load_dwordx2 s[16:17], s[0:1], 56
    s_load_dwordx2 s[18:19], s[0:1], 80
    v_lshrrev_b32 v1, 6, v0
    v_and_b32 v2, 63, v0
    v_readfirstlane_b32 s3, v1
    s_sub_u32 s2, s2, 253
    s_lshl_b32 s33, s2, 4
    s_add_u32 s33, s33, s3
    s_add_u32 s62, s33, 300
    s_cmp_ge_u32 s33, 32
    s_cselect_b32 s34, 64, 32
    s_add_u32 s33, s33, s34
    v_and_b32 v4, 31, v2
    v_lshrrev_b32 v5, 5, v2
    v_lshlrev_b32 v6, 11, v5
    v_lshl_add_u32 v6, v4, 1, v6
    v_lshlrev_b32 v3, 4, v2
    s_waitcnt lgkmcnt(0)
    s_add_u32 s28, s18, 10485760
    s_addc_u32 s29, s19, 0
    s_mov_b32 s30, 113152
    s_mov_b32 s31, 0x20000
    s_mov_b32 s20, s12
    s_mov_b32 s21, s13
    s_mov_b32 s22, 69888
    s_mov_b32 s23, 0x20000
    s_cmp_ge_u32 s33, 105
    s_cbranch_scc1 K1_end
    s_cmp_ge_u32 s33, 101
    s_cbranch_scc1 K1_tab
    s_cmp_ge_u32 s33, 100
    s_cbranch_scc1 K1_wd
    s_cmp_ge_u32 s33, 96
    s_cbranch_scc1 K1_w4
    s_cmp_ge_u32 s33, 64
    s_cbranch_scc1 K1_end
    s_cmp_lt_u32 s33, 32
    s_cbranch_scc1 K1_end
    s_mov_b32 s24, s16
    s_mov_b32 s25, s17
    s_mov_b32 s26, 65536
    s_mov_b32 s27, 0x20000
    s_lshr_b32 s35, s33, 5
    s_lshl_b32 s37, s35, 15
K1_wf:
    s_bfe_u32 s34, s33, 0x20003
    s_and_b32 s35, s33, 7
    s_lshl_b32 s35, s35, 12
    s_lshl_b32 s34, s34, 6
    s_add_u32 s34, s34, s35
    s_add_u32 s34, s34, s37
    s_lshl_b32 s36, s33, 10
    buffer_load_ushort v16, v6, s[24:27], s34 offen offset:0
    buffer_load_ushort v17, v6, s[24:27], s34 offen offset:256
    buffer_load_ushort v18, v6, s[24:27], s34 offen offset:512
    buffer_load_ushort v19, v6, s[24:27], s34 offen offset:768
    buffer_load_ushort v20, v6, s[24:27], s34 offen offset:1024
    buffer_load_ushort v21, v6, s[24:27], s34 offen offset:1280
    buffer_load_ushort v22, v6, s[24:27], s34 offen offset:1536
    buffer_load_ushort v23, v6, s[24:27], s34 offen offset:1792
    s_waitcnt vmcnt(0)
    v_lshl_or_b32 v24, v17, 16, v16
    v_lshl_or_b32 v25, v19, 16, v18
    v_lshl_or_b32 v26, v21, 16, v20
    v_lshl_or_b32 v27, v23, 16, v22
    buffer_store_dwordx4 v[24:27], v3, s[28:31], s36 offen sc0 sc1
    s_endpgm
K1_w4:
    s_sub_u32 s33, s33, 96
    s_lshl_b32 s34, s33, 6
    s_add_u32 s34, s34, 65792
    s_lshl_b32 s36, s33, 10
    s_add_u32 s36, s36, 100352
    buffer_load_ushort v16, v6, s[20:23], s34 offen offset:0
    buffer_load_ushort v17, v6, s[20:23], s34 offen offset:256
    buffer_load_ushort v18, v6, s[20:23], s34 offen offset:512
    buffer_load_ushort v19, v6, s[20:23], s34 offen offset:768
    buffer_load_ushort v20, v6, s[20:23], s34 offen offset:1024
    buffer_load_ushort v21, v6, s[20:23], s34 offen offset:1280
    buffer_load_ushort v22, v6, s[20:23], s34 offen offset:1536
    buffer_load_ushort v23, v6, s[20:23], s34 offen offset:1792
    s_mov_b32 s40, 0x3fb8aa3b
    s_waitcnt vmcnt(0)
    v_lshlrev_b32 v16, 16, v16
    v_mul_f32 v16, s40, v16
    v_lshlrev_b32 v17, 16, v17
    v_mul_f32 v17, s40, v17
    v_lshlrev_b32 v18, 16, v18
    v_mul_f32 v18, s40, v18
    v_lshlrev_b32 v19, 16, v19
    v_mul_f32 v19, s40, v19
    v_lshlrev_b32 v20, 16, v20
    v_mul_f32 v20, s40, v20
    v_lshlrev_b32 v21, 16, v21
    v_mul_f32 v21, s40, v21
    v_lshlrev_b32 v22, 16, v22
    v_mul_f32 v22, s40, v22
    v_lshlrev_b32 v23, 16, v23
    v_mul_f32 v23, s40, v23
    v_cvt_pk_bf16_f32 v24, v16, v17
    v_cvt_pk_bf16_f32 v25, v18, v19
    v_cvt_pk_bf16_f32 v26, v20, v21
    v_cvt_pk_bf16_f32 v27, v22, v23
    buffer_store_dwordx4 v[24:27], v3, s[28:31], s36 offen sc0 sc1
    s_endpgm
K1_wd:
    s_mov_b32 s24, s14
    s_mov_b32 s25, s15
    s_mov_b32 s26, 256
    s_mov_b32 s27, 0x20000
    v_lshlrev_b32 v7, 1, v2
    s_mov_b32 s34, 65536
    buffer_load_ushort v16, v7, s[20:23], s34 offen
    buffer_load_ushort v17, v7, s[20:23], s34 offen offset:128
    buffer_load_ushort v18, v7, s[24:27], 0 offen
    buffer_load_ushort v19, v7, s[24:27], 0 offen offset:128
    s_mov_b32 s40, 0x3fb8aa3b
    s_mov_b32 s41, 0x3f317218
    v_lshlrev_b32 v8, 2, v2
    v_mov_b32 v25, 0
    v_mov_b32 v26, 0
    v_mov_b32 v27, 0
    v_mov_b32 v29, 0
    v_mov_b32 v30, 0
    v_mov_b32 v31, 0
    s_waitcnt vmcnt(0)
    v_lshlrev_b32 v16, 16, v16
    v_mul_f32 v16, s40, v16
    v_cvt_pk_bf16_f32 v20, v16, v16
    v_and_b32 v22, 0xffff0000, v20
    v_sub_f32 v22, v16, v22
    v_cvt_pk_bf16_f32 v24, v16, v22
    v_lshlrev_b32 v18, 16, v18
    v_mul_f32 v18, s41, v18
    v_lshlrev_b32 v17, 16, v17
    v_mul_f32 v17, s40, v17
    v_cvt_pk_bf16_f32 v21, v17, v17
    v_and_b32 v23, 0xffff0000, v21
    v_sub_f32 v23, v17, v23
    v_cvt_pk_bf16_f32 v28, v17, v23
    v_lshlrev_b32 v19, 16, v19
    v_mul_f32 v19, s41, v19
    s_mov_b32 s34, 98304
    s_mov_b32 s35, 104448
    buffer_store_dwordx4 v[24:27], v3, s[28:31], s34 offen sc0 sc1
    buffer_store_dwordx4 v[28:31], v3, s[28:31], s34 offen offset:1024 sc0 sc1
    buffer_store_dword v18, v8, s[28:31], s35 offen sc0 sc1
    buffer_store_dword v19, v8, s[28:31], s35 offen offset:256 sc0 sc1
    s_endpgm
K1_tab:
    s_sub_u32 s33, s33, 101
    v_and_b32 v16, 31, v2
    v_lshrrev_b32 v17, 5, v2
    v_lshrrev_b32 v19, 4, v2
    v_xor_b32 v19, v19, v2
    v_and_b32 v19, 3, v19
    v_lshlrev_b32 v19, 4, v19
    s_lshl_b32 s34, s33, 6
    v_add_u32 v24, s34, v19
    v_lshlrev_b32 v19, 4, v16
    s_lshl_b32 s34, s33, 9
    s_add_u32 s34, s34, 147456
    v_add_u32 v19, s34, v19
    v_add_u32 v20, 10240, v19
    v_cmp_eq_u32 vcc, 0, v17
    s_nop 1
    v_cndmask_b32 v25, v20, v19, vcc
    v_and_b32 v19, 7, v16
    v_mul_u32_u24 v19, 272, v19
    v_lshl_add_u32 v19, v17, 3, v19
    s_lshl_b32 s34, s33, 6
    s_add_u32 s34, s34, 121856
    v_add_u32 v26, s34, v19
    v_lshlrev_b32 v19, 5, v16
    v_lshl_add_u32 v19, v17, 4, v19
    s_lshl_b32 s34, s33, 2
    s_add_u32 s34, s34, 139264
    v_add_u32 v27, s34, v19
    s_lshl_b32 s35, s33, 10
    s_add_u32 s35, s35, 109056
    buffer_store_dwordx4 v[24:27], v3, s[28:31], s35 offen sc0 sc1
    s_cmp_lg_u32 s33, 0
    s_cbranch_scc1 K1_tabd
    v_bfe_u32 v18, v16, 2, 2
    v_xor_b32 v19, v17, v18
    v_lshlrev_b32 v19, 4, v19
    v_lshl_add_u32 v28, v16, 6, v19
    v_lshlrev_b32 v19, 4, v17
    v_lshl_add_u32 v29, v16, 5, v19
    v_and_b32 v20, 1, v2
    v_lshlrev_b32 v30, 4, v20
    v_add_u32 v30, -32, v30
    v_lshlrev_b32 v19, 6, v16
    v_lshlrev_b32 v20, 4, v16
    v_add_u32 v20, 2048, v20
    v_cndmask_b32 v19, v20, v19, vcc
    v_add_u32 v31, 1024, v19
    v_bfe_u32 v19, v2, 2, 2
    v_lshlrev_b32 v19, 6, v19
    v_lshl_add_u32 v19, v17, 8, v19
    v_and_b32 v20, 16, v2
    v_lshl_add_u32 v19, v20, 1, v19
    v_and_b32 v20, 3, v2
    v_lshl_add_u32 v19, v20, 3, v19
    v_add_u32 v32, 1024, v19
    v_lshrrev_b32 v19, 2, v2
    v_lshlrev_b32 v19, 4, v19
    v_add_u32 v33, 3076, v19
    v_lshrrev_b32 v19, 1, v2
    v_lshlrev_b32 v19, 4, v19
    v_add_u32 v34, 3080, v19
    v_mov_b32 v20, 2048
    v_cndmask_b32 v35, 0, v20, vcc
    v_and_b32 v19, 15, v16
    v_lshlrev_b32 v20, 3, v17
    v_sub_u32 v19, v19, v20
    v_and_b32 v20, 1, v19
    v_lshlrev_b32 v20, 4, v20
    v_mov_b32 v18, 0x3f80
    v_lshlrev_b32 v20, v20, v18
    v_cmp_gt_u32 vcc, 8, v19
    s_nop 1
    v_cndmask_b32 v20, 0, v20, vcc
    v_bfe_u32 v19, v19, 1, 2
    v_lshrrev_b32 v18, 4, v16
    v_lshl_add_u32 v19, v18, 2, v19
    v_cmp_eq_u32 vcc, 0, v19
    s_nop 1
    v_cndmask_b32 v36, 0, v20, vcc
    v_cmp_eq_u32 vcc, 1, v19
    s_nop 1
    v_cndmask_b32 v37, 0, v20, vcc
    v_cmp_eq_u32 vcc, 2, v19
    s_nop 1
    v_cndmask_b32 v38, 0, v20, vcc
    v_cmp_eq_u32 vcc, 3, v19
    s_nop 1
    v_cndmask_b32 v39, 0, v20, vcc
    v_cmp_eq_u32 vcc, 4, v19
    s_nop 1
    v_cndmask_b32 v40, 0, v20, vcc
    v_cmp_eq_u32 vcc, 5, v19
    s_nop 1
    v_cndmask_b32 v41, 0, v20, vcc
    v_cmp_eq_u32 vcc, 6, v19
    s_nop 1
    v_cndmask_b32 v42, 0, v20, vcc
    v_cmp_eq_u32 vcc, 7, v19
    s_nop 1
    v_cndmask_b32 v43, 0, v20, vcc
    s_mov_b32 s35, 104960
    buffer_store_dwordx4 v[36:39], v3, s[28:31], s35 offen sc0 sc1
    buffer_store_dwordx4 v[40:43], v3, s[28:31], s35 offen offset:1024 sc0 sc1
    buffer_store_dwordx4 v[28:31], v3, s[28:31], s35 offen offset:2048 sc0 sc1
    buffer_store_dwordx4 v[32:35], v3, s[28:31], s35 offen offset:3072 sc0 sc1
K1_tabd:
    s_endpgm
K1_end:
    s_endpgm
.globl standalone__cheap_equivariant_egnn__graph_kernel
.p2align 8
.type standalone__cheap_equivariant_egnn__graph_kernel,@function
standalone__cheap_equivariant_egnn__graph_kernel:
    s_cmp_ge_u32 s2, 250
    s_cbranch_scc1 K2_end
    s_load_dwordx2 s[4:5], s[0:1], 80
    s_load_dwordx4 s[64:67], s[0:1], 0
    s_load_dwordx2 s[68:69], s[0:1], 16
    s_load_dwordx2 s[70:71], s[0:1], 64
    s_mov_b32 s39, s2
    v_lshrrev_b32 v23, 4, v0
    v_lshlrev_b32 v24, 6, v23
    v_lshl_add_u32 v24, v0, 2, v24
    v_mul_u32_u24 v100, 2500, v23
    v_lshrrev_b32 v23, 6, v0
    s_nop 0
    v_readfirstlane_b32 s36, v23
    v_and_b32 v124, 63, v0
    s_lshl_b32 s3, s39, 13
    v_lshlrev_b32 v23, 4, v124
    s_and_b32 s37, s36, 3
    s_lshr_b32 s38, s36, 2
    s_mul_i32 s43, s36, 3072
    s_add_u32 s43, s43, 72704
    s_add_u32 s84, s43, 1024
    s_add_u32 s85, s43, 2048
    s_mul_i32 s63, s39, 10240
    s_add_u32 s63, s63, 4718592
    s_cmp_ge_u32 s36, 10
    s_cselect_b32 s63, 10573824, s63
    s_lshl_b32 s72, s36, 10
    s_add_u32 s63, s63, s72
    s_add_u32 s72, s72, 147456
    s_mul_i32 s93, s39, 10240
    s_waitcnt lgkmcnt(0)
    s_mov_b32 s8, s4
    s_mov_b32 s9, s5
    s_mov_b32 s10, 10696832
    s_mov_b32 s11, 0x20000
    buffer_load_dword v56, v24, s[8:11], s3 offen
    buffer_load_dword v72, v24, s[8:11], s3 offen offset:64
    s_mov_b32 s62, 10616832
    s_mov_b32 s90, s63
    s_mov_b32 s91, s72
    s_cmp_ge_u32 s36, 10
    s_cbranch_scc1 K2_nx
    s_cmp_ge_u32 s36, 8
    s_cbranch_scc1 K2_x8
    s_lshl_b32 s3, s36, 10
    s_add_u32 m0, s3, 72704
    s_add_u32 s3, s3, 10590720
    buffer_load_dwordx4 v23, s[8:11], s3 offen lds
    s_branch K2_xh
K2_x8:
    s_cmp_eq_u32 s36, 9
    s_cbranch_scc1 K2_x9
    s_mul_i32 s3, s39, 320
    s_add_u32 s3, s3, 10616832
    s_mov_b32 m0, 640
    s_mov_b64 exec, 0xfffff
    buffer_load_dwordx4 v23, s[8:11], s3 offen lds
    s_mov_b64 exec, -1
    s_branch K2_xh
K2_x9:
    s_mov_b32 s3, 10590208
    s_mov_b32 m0, 128
    s_mov_b32 exec_hi, 0
    buffer_load_dwordx4 v23, s[8:11], s3 offen lds
    s_mov_b64 exec, -1
K2_xh:
K2_nx:
    s_mov_b32 m0, s91
    s_nop 0
    buffer_load_dwordx4 v23, s[8:11], s90 offen lds
    s_mov_b32 s12, s68
    s_mov_b32 s13, s69
    s_mov_b32 s14, 5120000
    s_mov_b32 s15, 0x20000
    s_mov_b32 s16, s70
    s_mov_b32 s17, s71
    s_mov_b32 s18, 2620000
    s_mov_b32 s19, 0x20000
    s_mov_b32 s20, s64
    s_mov_b32 s21, s65
    s_mov_b32 s22, 2560000
    s_mov_b32 s23, 0x20000
    s_mov_b32 s32, s66
    s_mov_b32 s33, s67
    s_mov_b32 s34, 60000
    s_mov_b32 s35, 0x20000
    s_mov_b32 s40, 1.0
    s_mov_b32 s41, 1.0
    s_mov_b32 s42, 0
    s_mov_b32 s94, 0
    s_mov_b32 s88, 0
    s_mov_b32 s89, 10485760
    s_mov_b32 s44, 2097152
    s_mul_i32 s45, s39, 240
    s_mov_b32 s60, 0x3f317218
    s_mov_b32 s61, 0x3fb8aa3b
K2_batch:
    v_lshlrev_b32 v25, 4, v0
    v_mov_b32 v88, 0
    v_mov_b32 v89, 0
    v_mov_b32 v90, 0
    v_mov_b32 v91, 0
    s_cmp_ge_u32 s36, 8
    s_cbranch_scc1 K2_zfd
    ds_write_b128 v25, v[88:91] offset:1024
    ds_write_b128 v25, v[88:91] offset:9216
    ds_write_b128 v25, v[88:91] offset:17408
    ds_write_b128 v25, v[88:91] offset:25600
    ds_write_b128 v25, v[88:91] offset:33792
    ds_write_b128 v25, v[88:91] offset:41984
    ds_write_b128 v25, v[88:91] offset:50176
    v_add_u32 v24, 57344, v25
    ds_write_b128 v24, v[88:91] offset:1024
    v_cmp_gt_u32 vcc, 384, v0
    s_nop 0
    s_and_saveexec_b64 s[76:77], vcc
    s_cbranch_execz K2_zf
    ds_write_b128 v24, v[88:91] offset:9216
K2_zf:
    s_mov_b64 exec, s[76:77]
    v_cmp_gt_u32 vcc, 6, v0
    s_nop 0
    s_and_saveexec_b64 s[76:77], vcc
    s_cbranch_execz K2_cz
    ds_write_b128 v25, v[88:91]
K2_cz:
    s_mov_b64 exec, s[76:77]
K2_zfd:
    v_mov_b32 v101, 1
    v_mov_b32 v3, 0x3f80
    s_cmp_lg_u32 s42, 0
    s_cbranch_scc1 K2_slowload
    v_lshlrev_b32 v23, 4, v124
    v_add_u32 v23, 72704, v23
    s_lshl_b32 s3, s37, 10
    v_add_u32 v24, s3, v23
    v_and_b32 v102, 7, v0
    v_lshlrev_b32 v102, 2, v102
    s_waitcnt vmcnt(1) lgkmcnt(0)
K2_z:
    s_barrier
    ds_read_b128 v[4:7], v23 offset:2048
    ds_read_b128 v[8:11], v23 offset:3072
    ds_read_b128 v[12:15], v24 offset:4096
    ds_read_b128 v[32:35], v23
    ds_read_b128 v[36:39], v23 offset:1024
    v_lshrrev_b32 v68, 20, v56
    v_add_u32 v68, v68, v100
    v_lshrrev_b32 v84, 20, v72
    v_add_u32 v84, v84, v100
K2_sort:
    v_cmp_gt_u32 s[80:81], -2, v56
    v_cmp_gt_u32 s[82:83], -2, v72
    v_cmp_eq_u32 vcc, -2, v72
    s_cbranch_vccz K2_nomark
    v_mov_b32 v23, 0
    v_mov_b32 v24, 0x10000
    s_mov_b64 exec, vcc
    ds_add_u32 v23, v24 offset:0
    s_mov_b64 exec, -1
K2_nomark:
    s_mov_b64 exec, s[80:81]
    s_cbranch_execz K2_p1a
    v_bfe_u32 v58, v56, 14, 6
    v_lshrrev_b32 v57, 1, v58
    v_and_b32 v57, 28, v57
    ds_add_rtn_u32 v60, v57, v101 offset:0
    v_lshlrev_b32 v61, 3, v58
    ds_read_b64 v[66:67], v61 offset:640
    v_and_b32 v59, 0x3fff, v56
    v_lshlrev_b32 v63, 3, v59
    buffer_load_dwordx2 v[64:65], v63, s[8:11], s62 offen
    v_lshlrev_b32 v59, 8, v59
    v_add_u32 v59, 256, v59
K2_p1a:
    s_mov_b64 exec, s[82:83]
    s_cbranch_execz K2_p1b
    v_bfe_u32 v74, v72, 14, 6
    v_lshrrev_b32 v73, 1, v74
    v_and_b32 v73, 28, v73
    ds_add_rtn_u32 v76, v73, v101 offset:0
    v_lshlrev_b32 v77, 3, v74
    ds_read_b64 v[82:83], v77 offset:640
    v_and_b32 v75, 0x3fff, v72
    v_lshlrev_b32 v79, 3, v75
    buffer_load_dwordx2 v[80:81], v79, s[8:11], s62 offen
    v_lshlrev_b32 v75, 8, v75
    v_add_u32 v75, 256, v75
K2_p1b:
    s_mov_b64 exec, -1
    s_waitcnt lgkmcnt(0)
    s_barrier
    ds_read_b32 v103, v102 offset:0
    s_waitcnt lgkmcnt(0)
    v_add_u32 v27, 31, v103
    v_lshrrev_b32 v25, 5, v27
    v_mov_b32 v27, v25
    s_nop 1
    v_add_u32_dpp v27, v27, v27 row_shr:1 row_mask:0xf bank_mask:0xf bound_ctrl:0
    s_nop 1
    v_add_u32_dpp v27, v27, v27 row_shr:2 row_mask:0xf bank_mask:0xf bound_ctrl:0
    s_nop 1
    v_add_u32_dpp v27, v27, v27 row_shr:4 row_mask:0xf bank_mask:0xf bound_ctrl:0
    s_nop 0
    v_readlane_b32 s51, v27, 4
    v_sub_u32 v25, v27, v25
    v_lshlrev_b32 v25, 5, v25
    s_cmp_lg_u32 s42, 0
    s_cbranch_scc1 K2_go
    s_cmp_gt_u32 s51, 28
    s_cbranch_scc1 K2_toslow
K2_go:
    ds_bpermute_b32 v63, v57, v25
    ds_bpermute_b32 v79, v73, v25
    s_waitcnt lgkmcnt(0)
    s_mov_b64 exec, s[80:81]
    s_cbranch_execz K2_p1c
    v_add_u32 v60, v60, v63
    v_lshrrev_b32 v61, 5, v60
    v_mul_u32_u24 v61, 2560, v61
    v_and_b32 v62, 31, v60
    v_lshl_add_u32 v63, v62, 4, v61
    v_lshlrev_b32 v68, 8, v68
    v_add_u32 v68, 256, v68
    ds_write_b32 v63, v59 offset:3076
    ds_write_b32 v63, v68 offset:3080
K2_p1c:
    s_mov_b64 exec, s[82:83]
    s_cbranch_execz K2_p1d
    v_add_u32 v76, v76, v79
    v_lshrrev_b32 v77, 5, v76
    v_mul_u32_u24 v77, 2560, v77
    v_and_b32 v78, 31, v76
    v_lshl_add_u32 v79, v78, 4, v77
    v_lshlrev_b32 v84, 8, v84
    v_add_u32 v84, 256, v84
    ds_write_b32 v79, v75 offset:3076
    ds_write_b32 v79, v84 offset:3080
K2_p1d:
    s_mov_b64 exec, -1
    s_mul_i32 s54, s38, s51
    s_add_u32 s55, s54, s51
    s_lshr_b32 s54, s54, 2
    s_lshr_b32 s55, s55, 2
    s_cmp_lg_u32 s42, 0
    s_cbranch_scc1 K2_slowaddr
K2_addr:
    s_mul_i32 s3, s54, 2560
    v_add_u32 v9, s3, v9
    v_add_u32 v10, s3, v10
    s_waitcnt lgkmcnt(0)
    s_barrier
    s_cmp_lg_u32 s94, 0
    s_cbranch_scc1 K2_cdone
    s_mov_b32 s94, 1
    v_add_u32 v4, s43, v4
    v_xor_b32 v1, 32, v4
    v_add_u32 v5, s85, v5
    v_mov_b32 v26, v5
    s_mul_i32 s72, s38, 2176
    v_add_u32 v14, s72, v14
    s_lshl_b32 s72, s38, 10
    v_add_u32 v15, s72, v15
    s_bfe_u32 s72, s39, 0x50003
    s_lshl_b32 s72, s72, 3
    s_and_b32 s73, s36, 7
    s_add_u32 s72, s72, s73
    s_lshl_b32 s72, s72, 7
    s_add_u32 s89, s72, 10518528
K2_cdone:
    v_mov_b32 v5, v26
    s_mov_b32 s92, s85
    s_mov_b32 s95, 1
    s_cmp_gt_u32 s51, 26
    s_cselect_b32 s89, 0, 1
    s_cbranch_scc1 K2_nosh
    s_lshl_b32 s3, s38, 10
    s_add_u32 s92, s3, 67584
    s_sub_u32 s3, s92, s85
    v_add_u32 v5, s3, v5
    s_cmp_eq_u32 s37, 0
    s_cselect_b32 s95, 1, 0
K2_nosh:
    s_cmp_ge_u32 s38, 2
    s_cbranch_scc1 K2_noq0
    s_cmp_ge_u32 s54, s55
    s_cbranch_scc1 K2_noq0
    ds_read2_b32 v[20:21], v9 offset0:0 offset1:64
    ds_read_b32 v22, v10
    s_waitcnt lgkmcnt(0)
    v_add_u32 v20, v20, v12
    v_add_u32 v21, v21, v12
    s_mov_b32 m0, s43
    v_lshrrev_b32 v22, 3, v22
    buffer_load_dwordx4 v20, s[8:11], s44 offen lds
    s_mov_b32 m0, s84
    v_add_u32 v22, v22, v6
    buffer_load_dwordx4 v21, s[8:11], s44 offen lds
    s_cmp_eq_u32 s95, 0
    s_cbranch_scc1 K2_fde0
    s_mov_b32 m0, s92
    s_nop 0
    buffer_load_dwordx4 v22, s[12:15], 0 offen lds
    s_waitcnt vmcnt(3)
    s_branch K2_fde1
K2_fde0:
    s_waitcnt vmcnt(2)
K2_fde1:
    s_branch K2_q0done
K2_noq0:
    s_waitcnt vmcnt(0)
K2_q0done:
    s_mov_b64 exec, s[80:81]
    s_cbranch_execz K2_p2a
    v_lshlrev_b32 v23, 16, v64
    v_lshlrev_b32 v24, 16, v66
    v_sub_f32 v23, v24, v23
    v_and_b32 v64, 0xffff0000, v64
    v_and_b32 v66, 0xffff0000, v66
    v_sub_f32 v24, v66, v64
    v_lshlrev_b32 v65, 16, v65
    v_lshlrev_b32 v67, 16, v67
    v_sub_f32 v25, v67, v65
    v_cvt_pk_bf16_f32 v64, v23, v24
    v_cvt_pk_bf16_f32 v65, v25, v25
    v_and_b32 v25, 7, v58
    v_lshl_add_u32 v60, v62, 6, v61
    v_lshl_add_u32 v60, v25, 1, v60
    ds_write_b16 v60, v3 offset:1024
    ds_write_b16 v60, v64 offset:1040
    ds_write_b16_d16_hi v60, v64 offset:1056
    ds_write_b16 v60, v65 offset:1072
    v_lshlrev_b32 v23, 16, v64
    v_and_b32 v24, 0xffff0000, v64
    v_and_b32 v25, 0xffff0000, v65
    v_mul_f32 v23, v23, v23
    v_fmac_f32 v23, v24, v24
    v_fmac_f32 v23, v25, v25
    v_cvt_pk_bf16_f32 v23, v23, v23
    ds_write_b32 v63, v23 offset:3072
K2_p2a:
    s_mov_b64 exec, s[82:83]
    s_cbranch_execz K2_p2b
    v_lshlrev_b32 v23, 16, v80
    v_lshlrev_b32 v24, 16, v82
    v_sub_f32 v23, v24, v23
    v_and_b32 v80, 0xffff0000, v80
    v_and_b32 v82, 0xffff0000, v82
    v_sub_f32 v24, v82, v80
    v_lshlrev_b32 v81, 16, v81
    v_lshlrev_b32 v83, 16, v83
    v_sub_f32 v25, v83, v81
    v_cvt_pk_bf16_f32 v80, v23, v24
    v_cvt_pk_bf16_f32 v81, v25, v25
    v_and_b32 v25, 7, v74
    v_lshl_add_u32 v76, v78, 6, v77
    v_lshl_add_u32 v76, v25, 1, v76
    ds_write_b16 v76, v3 offset:1024
    ds_write_b16 v76, v80 offset:1040
    ds_write_b16_d16_hi v76, v80 offset:1056
    ds_write_b16 v76, v81 offset:1072
    v_lshlrev_b32 v23, 16, v80
    v_and_b32 v24, 0xffff0000, v80
    v_and_b32 v25, 0xffff0000, v81
    v_mul_f32 v23, v23, v23
    v_fmac_f32 v23, v24, v24
    v_fmac_f32 v23, v25, v25
    v_cvt_pk_bf16_f32 v23, v23, v23
    ds_write_b32 v79, v23 offset:3072
K2_p2b:
    s_mov_b64 exec, -1
    v_readlane_b32 s47, v27, 0
    v_readlane_b32 s48, v27, 1
    v_readlane_b32 s49, v27, 2
    v_readlane_b32 s50, v27, 3
    s_mov_b32 s46, 0
    s_mul_i32 s3, s54, 2560
    v_add_u32 v7, s3, v7
    v_add_u32 v8, s3, v8
    s_mov_b32 s56, s54
    v_add_u32 v24, -1, v103
    v_and_b32 v24, 31, v24
    v_cmp_gt_u32 s[52:53], 16, v24
    s_waitcnt lgkmcnt(0)
    s_barrier
    s_cmp_eq_u32 s42, 1
    s_cbranch_scc1 K2_slowzero
K2_zdone:
    s_cmp_lt_u32 s38, 2
    s_cbranch_scc1 K2_nolate
    s_cmp_ge_u32 s54, s55
    s_cbranch_scc1 K2_nolate
    ds_read2_b32 v[20:21], v9 offset0:0 offset1:64
    ds_read_b32 v22, v10
    s_waitcnt lgkmcnt(0)
    v_add_u32 v20, v20, v12
    v_add_u32 v21, v21, v12
    s_mov_b32 m0, s43
    v_lshrrev_b32 v22, 3, v22
    buffer_load_dwordx4 v20, s[8:11], s44 offen lds
    s_mov_b32 m0, s84
    v_add_u32 v22, v22, v6
    buffer_load_dwordx4 v21, s[8:11], s44 offen lds
    s_cmp_eq_u32 s95, 0
    s_cbranch_scc1 K2_fdl0
    s_mov_b32 m0, s92
    s_nop 0
    buffer_load_dwordx4 v22, s[12:15], 0 offen lds
    s_branch K2_fdl1
K2_fdl0:
K2_fdl1:
K2_nolate:
    s_cmp_eq_u32 s89, 0
    s_cbranch_scc1 K2_shd
    s_cmp_ge_u32 s54, s55
    s_cbranch_scc1 K2_shd
    s_lshl_b32 s3, s38, 2
    v_mov_b32 v23, s3
    s_cmp_eq_u32 s37, 0
    s_cbranch_scc0 K2_shw
    s_waitcnt vmcnt(0)
    v_mov_b32 v24, 1
    s_mov_b64 exec, 1
    ds_write_b32 v23, v24 offset:64
    s_mov_b64 exec, -1
    s_branch K2_shd
K2_shw:
    s_mov_b32 s72, 0
K2_shp:
    ds_read_b32 v24, v23 offset:64
    s_waitcnt lgkmcnt(0)
    v_readfirstlane_b32 s3, v24
    s_nop 0
    s_cmp_lg_u32 s3, 0
    s_cbranch_scc1 K2_shd
    s_add_u32 s72, s72, 1
    s_cmp_lt_u32 s72, 0x400000
    s_cbranch_scc1 K2_shp
K2_shd:
    v_add_u32 v9, 2560, v9
    v_add_u32 v10, 2560, v10
    v_and_b32 v23, 63, v0
    v_lshlrev_b32 v23, 4, v23
    s_lshl_b32 s3, s37, 10
    s_add_u32 s3, s3, 159744
    v_add_u32 v23, s3, v23
    ds_read_b128 v[28:31], v23
K2_g0:
    s_min_u32 s57, s55, s47
    s_cmp_ge_u32 s56, s57
    s_cbranch_scc1 K2_g0_done
    ds_read_b128 v[16:19], v13
    s_sub_u32 s59, s47, 1
    s_bitcmp1_b32 s52, 0
    s_cselect_b32 s59, s59, -1
    s_mov_b32 s58, 1
K2_g0_loop:
    ds_read_b128 v[84:87], v7
    s_waitcnt vmcnt(0)
    ds_read_b128 v[80:83], v5
    v_mov_b32 v5, v26
    ds_read_b128 v[72:75], v4
    ds_read_b128 v[76:79], v1
    ds_read_b64_tr_b16 v[112:113], v8 offset:0
    ds_read_b64_tr_b16 v[114:115], v8 offset:512
    ds_read_b64_tr_b16 v[116:117], v8 offset:1024
    ds_read_b64_tr_b16 v[118:119], v8 offset:1536
    ds_read2_b32 v[20:21], v9 offset0:0 offset1:64
    ds_read_b32 v22, v10
    s_sub_u32 s72, s55, s56
    s_cmp_ge_u32 s72, 4
    s_cbranch_scc1 K2_g0_p3
    s_cmp_ge_u32 s72, 3
    s_cbranch_scc1 K2_g0_p2
    s_cmp_ge_u32 s72, 2
    s_cbranch_scc1 K2_g0_p1
    s_setprio 0
    s_branch K2_g0_pd
K2_g0_p1:
    s_setprio 1
    s_branch K2_g0_pd
K2_g0_p2:
    s_setprio 2
    s_branch K2_g0_pd
K2_g0_p3:
    s_setprio 3
K2_g0_pd:
    s_waitcnt lgkmcnt(9)
    v_mfma_f32_32x32x16_bf16 v[56:71], v[84:87], v[16:19], 0
    s_waitcnt lgkmcnt(8)
    v_mfma_f32_32x32x16_bf16 v[56:71], v[80:83], v[28:31], v[56:71]
    s_waitcnt lgkmcnt(6)
    v_mfma_f32_32x32x16_bf16 v[56:71], v[72:75], v[32:35], v[56:71]
    v_mfma_f32_32x32x16_bf16 v[56:71], v[76:79], v[36:39], v[56:71]
    s_add_u32 s72, s56, 1
    v_add_u32 v9, 2560, v9
    v_add_u32 v10, 2560, v10
    v_add_u32 v7, 2560, v7
    v_add_u32 v8, 2560, v8
    s_waitcnt lgkmcnt(0)
    s_cmp_ge_u32 s72, s55
    s_cbranch_scc1 K2_g0_last
    v_add_u32 v20, v20, v12
    v_add_u32 v21, v21, v12
    s_mov_b32 m0, s43
    v_lshrrev_b32 v22, 3, v22
    buffer_load_dwordx4 v20, s[8:11], s44 offen lds
    s_mov_b32 m0, s84
    v_add_u32 v22, v22, v6
    buffer_load_dwordx4 v21, s[8:11], s44 offen lds
    s_mov_b32 m0, s85
    s_nop 0
    buffer_load_dwordx4 v22, s[12:15], 0 offen lds
K2_g0_nodma:
    s_nop 3
    v_exp_f32 v88, -v56
    v_exp_f32 v89, -v57
    v_exp_f32 v90, -v58
    v_exp_f32 v91, -v59
    v_exp_f32 v92, -v60
    v_exp_f32 v93, -v61
    v_exp_f32 v94, -v62
    v_exp_f32 v95, -v63
    v_pk_add_f32 v[88:89], v[88:89], s[40:41]
    v_pk_add_f32 v[90:91], v[90:91], s[40:41]
    v_pk_add_f32 v[92:93], v[92:93], s[40:41]
    v_pk_add_f32 v[94:95], v[94:95], s[40:41]
    v_rcp_f32 v88, v88
    v_rcp_f32 v89, v89
    v_rcp_f32 v90, v90
    v_rcp_f32 v91, v91
    v_rcp_f32 v92, v92
    v_rcp_f32 v93, v93
    v_rcp_f32 v94, v94
    v_rcp_f32 v95, v95
    v_pk_mul_f32 v[88:89], v[88:89], v[56:57]
    v_pk_mul_f32 v[90:91], v[90:91], v[58:59]
    v_pk_mul_f32 v[92:93], v[92:93], v[60:61]
    v_pk_mul_f32 v[94:95], v[94:95], v[62:63]
    v_cvt_pk_bf16_f32 v104, v88, v89
    v_cvt_pk_bf16_f32 v105, v90, v91
    v_cvt_pk_bf16_f32 v106, v92, v93
    v_cvt_pk_bf16_f32 v107, v94, v95
    s_waitcnt lgkmcnt(0)
    s_cmp_eq_u32 s58, 0
    s_cbranch_scc1 K2_g0_acc
    v_mfma_f32_32x32x16_bf16 v[40:55], v[104:107], v[112:115], 0
    s_mov_b32 s58, 0
    s_branch K2_g0_acc2
K2_g0_acc:
    v_mfma_f32_32x32x16_bf16 v[40:55], v[104:107], v[112:115], v[40:55]
K2_g0_acc2:
    s_cmp_eq_u32 s56, s59
    s_cbranch_scc1 K2_g0_skip2
    v_exp_f32 v96, -v64
    v_exp_f32 v97, -v65
    v_exp_f32 v98, -v66
    v_exp_f32 v99, -v67
    v_exp_f32 v100, -v68
    v_exp_f32 v101, -v69
    v_exp_f32 v102, -v70
    v_exp_f32 v103, -v71
    v_pk_add_f32 v[96:97], v[96:97], s[40:41]
    v_pk_add_f32 v[98:99], v[98:99], s[40:41]
    v_pk_add_f32 v[100:101], v[100:101], s[40:41]
    v_pk_add_f32 v[102:103], v[102:103], s[40:41]
    v_rcp_f32 v96, v96
    v_rcp_f32 v97, v97
    v_rcp_f32 v98, v98
    v_rcp_f32 v99, v99
    v_rcp_f32 v100, v100
    v_rcp_f32 v101, v101
    v_rcp_f32 v102, v102
    v_rcp_f32 v103, v103
    v_pk_mul_f32 v[96:97], v[96:97], v[64:65]
    v_pk_mul_f32 v[98:99], v[98:99], v[66:67]
    v_pk_mul_f32 v[100:101], v[100:101], v[68:69]
    v_pk_mul_f32 v[102:103], v[102:103], v[70:71]
    v_cvt_pk_bf16_f32 v108, v96, v97
    v_cvt_pk_bf16_f32 v109, v98, v99
    v_cvt_pk_bf16_f32 v110, v100, v101
    v_cvt_pk_bf16_f32 v111, v102, v103
    s_nop 1
    v_mfma_f32_32x32x16_bf16 v[40:55], v[108:111], v[116:119], v[40:55]
K2_g0_skip2:
    s_add_u32 s56, s56, 1
    s_cmp_lt_u32 s56, s57
    s_cbranch_scc1 K2_g0_loop
    v_and_b32 v23, 16, v15
    s_lshl_b32 s72, s37, 7
    s_add_u32 s72, s72, 128
    v_add_u32 v23, s72, v23
    ds_read_b128 v[88:91], v23 offset:0
    ds_read_b128 v[92:95], v23 offset:32
    ds_read_b128 v[96:99], v23 offset:64
    ds_read_b128 v[100:103], v23 offset:96
    s_cmp_lg_u32 s42, 0
    s_cbranch_scc1 K2_g0_sflush
    s_nop 7
    v_cvt_pk_bf16_f32 v104, v40, v41
    v_cvt_pk_bf16_f32 v105, v42, v43
    v_cvt_pk_bf16_f32 v106, v44, v45
    v_cvt_pk_bf16_f32 v107, v46, v47
    v_cvt_pk_bf16_f32 v108, v48, v49
    v_cvt_pk_bf16_f32 v109, v50, v51
    v_cvt_pk_bf16_f32 v110, v52, v53
    v_cvt_pk_bf16_f32 v111, v54, v55
    s_mov_b32 exec_lo, 0xff
    s_mov_b32 exec_hi, 0xff
    ds_write_b64 v14, v[104:105] offset:0
    ds_write_b64 v14, v[106:107] offset:16
    ds_write_b64 v14, v[108:109] offset:32
    ds_write_b64 v14, v[110:111] offset:48
    s_mov_b64 exec, -1
    s_waitcnt lgkmcnt(4)
    v_pk_mul_f32 v[112:113], v[40:41], v[88:89]
    v_pk_fma_f32 v[112:113], v[42:43], v[90:91], v[112:113]
    v_pk_fma_f32 v[112:113], v[44:45], v[92:93], v[112:113]
    v_pk_fma_f32 v[112:113], v[46:47], v[94:95], v[112:113]
    v_pk_fma_f32 v[112:113], v[48:49], v[96:97], v[112:113]
    v_pk_fma_f32 v[112:113], v[50:51], v[98:99], v[112:113]
    v_pk_fma_f32 v[112:113], v[52:53], v[100:101], v[112:113]
    v_pk_fma_f32 v[112:113], v[54:55], v[102:103], v[112:113]
    v_add_f32 v112, v112, v113
    ds_write_b32 v15, v112 offset:0
    s_cmp_lg_u32 s37, 0
    s_cbranch_scc1 K2_g0_done
    s_lshl_b32 s72, s38, 2
    v_mov_b32 v23, s72
    v_mov_b32 v24, 1
    s_mov_b64 exec, 1
    ds_write_b32 v23, v24 offset:32
    s_mov_b64 exec, -1
K2_g0_done:
K2_g1:
    s_min_u32 s57, s55, s48
    s_cmp_ge_u32 s56, s57
    s_cbranch_scc1 K2_g1_done
    v_mad_u32_u24 v23, v11, 1, v13
    ds_read_b128 v[16:19], v23
    s_sub_u32 s59, s48, 1
    s_bitcmp1_b32 s52, 1
    s_cselect_b32 s59, s59, -1
    s_mov_b32 s58, 1
K2_g1_loop:
    ds_read_b128 v[84:87], v7
    s_waitcnt vmcnt(0)
    ds_read_b128 v[80:83], v5
    v_mov_b32 v5, v26
    ds_read_b128 v[72:75], v4
    ds_read_b128 v[76:79], v1
    ds_read_b64_tr_b16 v[112:113], v8 offset:0
    ds_read_b64_tr_b16 v[114:115], v8 offset:512
    ds_read_b64_tr_b16 v[116:117], v8 offset:1024
    ds_read_b64_tr_b16 v[118:119], v8 offset:1536
    ds_read2_b32 v[20:21], v9 offset0:0 offset1:64
    ds_read_b32 v22, v10
    s_sub_u32 s72, s55, s56
    s_cmp_ge_u32 s72, 4
    s_cbranch_scc1 K2_g1_p3
    s_cmp_ge_u32 s72, 3
    s_cbranch_scc1 K2_g1_p2
    s_cmp_ge_u32 s72, 2
    s_cbranch_scc1 K2_g1_p1
    s_setprio 0
    s_branch K2_g1_pd
K2_g1_p1:
    s_setprio 1
    s_branch K2_g1_pd
K2_g1_p2:
    s_setprio 2
    s_branch K2_g1_pd
K2_g1_p3:
    s_setprio 3
K2_g1_pd:
    s_waitcnt lgkmcnt(9)
    v_mfma_f32_32x32x16_bf16 v[56:71], v[84:87], v[16:19], 0
    s_waitcnt lgkmcnt(8)
    v_mfma_f32_32x32x16_bf16 v[56:71], v[80:83], v[28:31], v[56:71]
    s_waitcnt lgkmcnt(6)
    v_mfma_f32_32x32x16_bf16 v[56:71], v[72:75], v[32:35], v[56:71]
    v_mfma_f32_32x32x16_bf16 v[56:71], v[76:79], v[36:39], v[56:71]
    s_add_u32 s72, s56, 1
    v_add_u32 v9, 2560, v9
    v_add_u32 v10, 2560, v10
    v_add_u32 v7, 2560, v7
    v_add_u32 v8, 2560, v8
    s_waitcnt lgkmcnt(0)
    s_cmp_ge_u32 s72, s55
    s_cbranch_scc1 K2_g1_last
    v_add_u32 v20, v20, v12
    v_add_u32 v21, v21, v12
    s_mov_b32 m0, s43
    v_lshrrev_b32 v22, 3, v22
    buffer_load_dwordx4 v20, s[8:11], s44 offen lds
    s_mov_b32 m0, s84
    v_add_u32 v22, v22, v6
    buffer_load_dwordx4 v21, s[8:11], s44 offen lds
    s_mov_b32 m0, s85
    s_nop 0
    buffer_load_dwordx4 v22, s[12:15], 0 offen lds
K2_g1_nodma:
    s_nop 3
    v_exp_f32 v88, -v56
    v_exp_f32 v89, -v57
    v_exp_f32 v90, -v58
    v_exp_f32 v91, -v59
    v_exp_f32 v92, -v60
    v_exp_f32 v93, -v61
    v_exp_f32 v94, -v62
    v_exp_f32 v95, -v63
    v_pk_add_f32 v[88:89], v[88:89], s[40:41]
    v_pk_add_f32 v[90:91], v[90:91], s[40:41]
    v_pk_add_f32 v[92:93], v[92:93], s[40:41]
    v_pk_add_f32 v[94:95], v[94:95], s[40:41]
    v_rcp_f32 v88, v88
    v_rcp_f32 v89, v89
    v_rcp_f32 v90, v90
    v_rcp_f32 v91, v91
    v_rcp_f32 v92, v92
    v_rcp_f32 v93, v93
    v_rcp_f32 v94, v94
    v_rcp_f32 v95, v95
    v_pk_mul_f32 v[88:89], v[88:89], v[56:57]
    v_pk_mul_f32 v[90:91], v[90:91], v[58:59]
    v_pk_mul_f32 v[92:93], v[92:93], v[60:61]
    v_pk_mul_f32 v[94:95], v[94:95], v[62:63]
    v_cvt_pk_bf16_f32 v104, v88, v89
    v_cvt_pk_bf16_f32 v105, v90, v91
    v_cvt_pk_bf16_f32 v106, v92, v93
    v_cvt_pk_bf16_f32 v107, v94, v95
    s_waitcnt lgkmcnt(0)
    s_cmp_eq_u32 s58, 0
    s_cbranch_scc1 K2_g1_acc
    v_mfma_f32_32x32x16_bf16 v[40:55], v[104:107], v[112:115], 0
    s_mov_b32 s58, 0
    s_branch K2_g1_acc2
K2_g1_acc:
    v_mfma_f32_32x32x16_bf16 v[40:55], v[104:107], v[112:115], v[40:55]
K2_g1_acc2:
    s_cmp_eq_u32 s56, s59
    s_cbranch_scc1 K2_g1_skip2
    v_exp_f32 v96, -v64
    v_exp_f32 v97, -v65
    v_exp_f32 v98, -v66
    v_exp_f32 v99, -v67
    v_exp_f32 v100, -v68
    v_exp_f32 v101, -v69
    v_exp_f32 v102, -v70
    v_exp_f32 v103, -v71
    v_pk_add_f32 v[96:97], v[96:97], s[40:41]
    v_pk_add_f32 v[98:99], v[98:99], s[40:41]
    v_pk_add_f32 v[100:101], v[100:101], s[40:41]
    v_pk_add_f32 v[102:103], v[102:103], s[40:41]
    v_rcp_f32 v96, v96
    v_rcp_f32 v97, v97
    v_rcp_f32 v98, v98
    v_rcp_f32 v99, v99
    v_rcp_f32 v100, v100
    v_rcp_f32 v101, v101
    v_rcp_f32 v102, v102
    v_rcp_f32 v103, v103
    v_pk_mul_f32 v[96:97], v[96:97], v[64:65]
    v_pk_mul_f32 v[98:99], v[98:99], v[66:67]
    v_pk_mul_f32 v[100:101], v[100:101], v[68:69]
    v_pk_mul_f32 v[102:103], v[102:103], v[70:71]
    v_cvt_pk_bf16_f32 v108, v96, v97
    v_cvt_pk_bf16_f32 v109, v98, v99
    v_cvt_pk_bf16_f32 v110, v100, v101
    v_cvt_pk_bf16_f32 v111, v102, v103
    s_nop 1
    v_mfma_f32_32x32x16_bf16 v[40:55], v[108:111], v[116:119], v[40:55]
K2_g1_skip2:
    s_add_u32 s56, s56, 1
    s_cmp_lt_u32 s56, s57
    s_cbranch_scc1 K2_g1_loop
    v_and_b32 v23, 16, v15
    s_lshl_b32 s72, s37, 7
    s_add_u32 s72, s72, 128
    v_add_u32 v23, s72, v23
    ds_read_b128 v[88:91], v23 offset:0
    ds_read_b128 v[92:95], v23 offset:32
    ds_read_b128 v[96:99], v23 offset:64
    ds_read_b128 v[100:103], v23 offset:96
    s_cmp_lg_u32 s42, 0
    s_cbranch_scc1 K2_g1_sflush
    s_nop 7
    v_cvt_pk_bf16_f32 v104, v40, v41
    v_cvt_pk_bf16_f32 v105, v42, v43
    v_cvt_pk_bf16_f32 v106, v44, v45
    v_cvt_pk_bf16_f32 v107, v46, v47
    v_cvt_pk_bf16_f32 v108, v48, v49
    v_cvt_pk_bf16_f32 v109, v50, v51
    v_cvt_pk_bf16_f32 v110, v52, v53
    v_cvt_pk_bf16_f32 v111, v54, v55
    s_mov_b32 exec_lo, 0xff
    s_mov_b32 exec_hi, 0xff
    ds_write_b64 v14, v[104:105] offset:2176
    ds_write_b64 v14, v[106:107] offset:2192
    ds_write_b64 v14, v[108:109] offset:2208
    ds_write_b64 v14, v[110:111] offset:2224
    s_mov_b64 exec, -1
    s_waitcnt lgkmcnt(4)
    v_pk_mul_f32 v[112:113], v[40:41], v[88:89]
    v_pk_fma_f32 v[112:113], v[42:43], v[90:91], v[112:113]
    v_pk_fma_f32 v[112:113], v[44:45], v[92:93], v[112:113]
    v_pk_fma_f32 v[112:113], v[46:47], v[94:95], v[112:113]
    v_pk_fma_f32 v[112:113], v[48:49], v[96:97], v[112:113]
    v_pk_fma_f32 v[112:113], v[50:51], v[98:99], v[112:113]
    v_pk_fma_f32 v[112:113], v[52:53], v[100:101], v[112:113]
    v_pk_fma_f32 v[112:113], v[54:55], v[102:103], v[112:113]
    v_add_f32 v112, v112, v113
    ds_write_b32 v15, v112 offset:1024
    s_cmp_lg_u32 s37, 0
    s_cbranch_scc1 K2_g1_done
    s_lshl_b32 s72, s38, 2
    v_mov_b32 v23, s72
    v_mov_b32 v24, 2
    s_mov_b64 exec, 1
    ds_write_b32 v23, v24 offset:36
    s_mov_b64 exec, -1
K2_g1_done:
K2_g2:
    s_min_u32 s57, s55, s49
    s_cmp_ge_u32 s56, s57
    s_cbranch_scc1 K2_g2_done
    v_mad_u32_u24 v23, v11, 2, v13
    ds_read_b128 v[16:19], v23
    s_sub_u32 s59, s49, 1
    s_bitcmp1_b32 s52, 2
    s_cselect_b32 s59, s59, -1
    s_mov_b32 s58, 1
K2_g2_loop:
    ds_read_b128 v[84:87], v7
    s_waitcnt vmcnt(0)
    ds_read_b128 v[80:83], v5
    v_mov_b32 v5, v26
    ds_read_b128 v[72:75], v4
    ds_read_b128 v[76:79], v1
    ds_read_b64_tr_b16 v[112:113], v8 offset:0
    ds_read_b64_tr_b16 v[114:115], v8 offset:512
    ds_read_b64_tr_b16 v[116:117], v8 offset:1024
    ds_read_b64_tr_b16 v[118:119], v8 offset:1536
    ds_read2_b32 v[20:21], v9 offset0:0 offset1:64
    ds_read_b32 v22, v10
    s_sub_u32 s72, s55, s56
    s_cmp_ge_u32 s72, 4
    s_cbranch_scc1 K2_g2_p3
    s_cmp_ge_u32 s72, 3
    s_cbranch_scc1 K2_g2_p2
    s_cmp_ge_u32 s72, 2
    s_cbranch_scc1 K2_g2_p1
    s_setprio 0
    s_branch K2_g2_pd
K2_g2_p1:
    s_setprio 1
    s_branch K2_g2_pd
K2_g2_p2:
    s_setprio 2
    s_branch K2_g2_pd
K2_g2_p3:
    s_setprio 3
K2_g2_pd:
    s_waitcnt lgkmcnt(9)
    v_mfma_f32_32x32x16_bf16 v[56:71], v[84:87], v[16:19], 0
    s_waitcnt lgkmcnt(8)
    v_mfma_f32_32x32x16_bf16 v[56:71], v[80:83], v[28:31], v[56:71]
    s_waitcnt lgkmcnt(6)
    v_mfma_f32_32x32x16_bf16 v[56:71], v[72:75], v[32:35], v[56:71]
    v_mfma_f32_32x32x16_bf16 v[56:71], v[76:79], v[36:39], v[56:71]
    s_add_u32 s72, s56, 1
    v_add_u32 v9, 2560, v9
    v_add_u32 v10, 2560, v10
    v_add_u32 v7, 2560, v7
    v_add_u32 v8, 2560, v8
    s_waitcnt lgkmcnt(0)
    s_cmp_ge_u32 s72, s55
    s_cbranch_scc1 K2_g2_last
    v_add_u32 v20, v20, v12
    v_add_u32 v21, v21, v12
    s_mov_b32 m0, s43
    v_lshrrev_b32 v22, 3, v22
    buffer_load_dwordx4 v20, s[8:11], s44 offen lds
    s_mov_b32 m0, s84
    v_add_u32 v22, v22, v6
    buffer_load_dwordx4 v21, s[8:11], s44 offen lds
    s_mov_b32 m0, s85
    s_nop 0
    buffer_load_dwordx4 v22, s[12:15], 0 offen lds
K2_g2_nodma:
    s_nop 3
    v_exp_f32 v88, -v56
    v_exp_f32 v89, -v57
    v_exp_f32 v90, -v58
    v_exp_f32 v91, -v59
    v_exp_f32 v92, -v60
    v_exp_f32 v93, -v61
    v_exp_f32 v94, -v62
    v_exp_f32 v95, -v63
    v_pk_add_f32 v[88:89], v[88:89], s[40:41]
    v_pk_add_f32 v[90:91], v[90:91], s[40:41]
    v_pk_add_f32 v[92:93], v[92:93], s[40:41]
    v_pk_add_f32 v[94:95], v[94:95], s[40:41]
    v_rcp_f32 v88, v88
    v_rcp_f32 v89, v89
    v_rcp_f32 v90, v90
    v_rcp_f32 v91, v91
    v_rcp_f32 v92, v92
    v_rcp_f32 v93, v93
    v_rcp_f32 v94, v94
    v_rcp_f32 v95, v95
    v_pk_mul_f32 v[88:89], v[88:89], v[56:57]
    v_pk_mul_f32 v[90:91], v[90:91], v[58:59]
    v_pk_mul_f32 v[92:93], v[92:93], v[60:61]
    v_pk_mul_f32 v[94:95], v[94:95], v[62:63]
    v_cvt_pk_bf16_f32 v104, v88, v89
    v_cvt_pk_bf16_f32 v105, v90, v91
    v_cvt_pk_bf16_f32 v106, v92, v93
    v_cvt_pk_bf16_f32 v107, v94, v95
    s_waitcnt lgkmcnt(0)
    s_cmp_eq_u32 s58, 0
    s_cbranch_scc1 K2_g2_acc
    v_mfma_f32_32x32x16_bf16 v[40:55], v[104:107], v[112:115], 0
    s_mov_b32 s58, 0
    s_branch K2_g2_acc2
K2_g2_acc:
    v_mfma_f32_32x32x16_bf16 v[40:55], v[104:107], v[112:115], v[40:55]
K2_g2_acc2:
    s_cmp_eq_u32 s56, s59
    s_cbranch_scc1 K2_g2_skip2
    v_exp_f32 v96, -v64
    v_exp_f32 v97, -v65
    v_exp_f32 v98, -v66
    v_exp_f32 v99, -v67
    v_exp_f32 v100, -v68
    v_exp_f32 v101, -v69
    v_exp_f32 v102, -v70
    v_exp_f32 v103, -v71
    v_pk_add_f32 v[96:97], v[96:97], s[40:41]
    v_pk_add_f32 v[98:99], v[98:99], s[40:41]
    v_pk_add_f32 v[100:101], v[100:101], s[40:41]
    v_pk_add_f32 v[102:103], v[102:103], s[40:41]
    v_rcp_f32 v96, v96
    v_rcp_f32 v97, v97
    v_rcp_f32 v98, v98
    v_rcp_f32 v99, v99
    v_rcp_f32 v100, v100
    v_rcp_f32 v101, v101
    v_rcp_f32 v102, v102
    v_rcp_f32 v103, v103
    v_pk_mul_f32 v[96:97], v[96:97], v[64:65]
    v_pk_mul_f32 v[98:99], v[98:99], v[66:67]
    v_pk_mul_f32 v[100:101], v[100:101], v[68:69]
    v_pk_mul_f32 v[102:103], v[102:103], v[70:71]
    v_cvt_pk_bf16_f32 v108, v96, v97
    v_cvt_pk_bf16_f32 v109, v98, v99
    v_cvt_pk_bf16_f32 v110, v100, v101
    v_cvt_pk_bf16_f32 v111, v102, v103
    s_nop 1
    v_mfma_f32_32x32x16_bf16 v[40:55], v[108:111], v[116:119], v[40:55]
K2_g2_skip2:
    s_add_u32 s56, s56, 1
    s_cmp_lt_u32 s56, s57
    s_cbranch_scc1 K2_g2_loop
    v_and_b32 v23, 16, v15
    s_lshl_b32 s72, s37, 7
    s_add_u32 s72, s72, 128
    v_add_u32 v23, s72, v23
    ds_read_b128 v[88:91], v23 offset:0
    ds_read_b128 v[92:95], v23 offset:32
    ds_read_b128 v[96:99], v23 offset:64
    ds_read_b128 v[100:103], v23 offset:96
    s_cmp_lg_u32 s42, 0
    s_cbranch_scc1 K2_g2_sflush
    s_nop 7
    v_cvt_pk_bf16_f32 v104, v40, v41
    v_cvt_pk_bf16_f32 v105, v42, v43
    v_cvt_pk_bf16_f32 v106, v44, v45
    v_cvt_pk_bf16_f32 v107, v46, v47
    v_cvt_pk_bf16_f32 v108, v48, v49
    v_cvt_pk_bf16_f32 v109, v50, v51
    v_cvt_pk_bf16_f32 v110, v52, v53
    v_cvt_pk_bf16_f32 v111, v54, v55
    s_mov_b32 exec_lo, 0xff
    s_mov_b32 exec_hi, 0xff
    ds_write_b64 v14, v[104:105] offset:4352
    ds_write_b64 v14, v[106:107] offset:4368
    ds_write_b64 v14, v[108:109] offset:4384
    ds_write_b64 v14, v[110:111] offset:4400
    s_mov_b64 exec, -1
    s_waitcnt lgkmcnt(4)
    v_pk_mul_f32 v[112:113], v[40:41], v[88:89]
    v_pk_fma_f32 v[112:113], v[42:43], v[90:91], v[112:113]
    v_pk_fma_f32 v[112:113], v[44:45], v[92:93], v[112:113]
    v_pk_fma_f32 v[112:113], v[46:47], v[94:95], v[112:113]
    v_pk_fma_f32 v[112:113], v[48:49], v[96:97], v[112:113]
    v_pk_fma_f32 v[112:113], v[50:51], v[98:99], v[112:113]
    v_pk_fma_f32 v[112:113], v[52:53], v[100:101], v[112:113]
    v_pk_fma_f32 v[112:113], v[54:55], v[102:103], v[112:113]
    v_add_f32 v112, v112, v113
    ds_write_b32 v15, v112 offset:2048
    s_cmp_lg_u32 s37, 0
    s_cbranch_scc1 K2_g2_done
    s_lshl_b32 s72, s38, 2
    v_mov_b32 v23, s72
    v_mov_b32 v24, 3
    s_mov_b64 exec, 1
    ds_write_b32 v23, v24 offset:40
    s_mov_b64 exec, -1
K2_g2_done:
K2_g3:
    s_min_u32 s57, s55, s50
    s_cmp_ge_u32 s56, s57
    s_cbranch_scc1 K2_g3_done
    v_mad_u32_u24 v23, v11, 3, v13
    ds_read_b128 v[16:19], v23
    s_sub_u32 s59, s50, 1
    s_bitcmp1_b32 s52, 3
    s_cselect_b32 s59, s59, -1
    s_mov_b32 s58, 1
K2_g3_loop:
    ds_read_b128 v[84:87], v7
    s_waitcnt vmcnt(0)
    ds_read_b128 v[80:83], v5
    v_mov_b32 v5, v26
    ds_read_b128 v[72:75], v4
    ds_read_b128 v[76:79], v1
    ds_read_b64_tr_b16 v[112:113], v8 offset:0
    ds_read_b64_tr_b16 v[114:115], v8 offset:512
    ds_read_b64_tr_b16 v[116:117], v8 offset:1024
    ds_read_b64_tr_b16 v[118:119], v8 offset:1536
    ds_read2_b32 v[20:21], v9 offset0:0 offset1:64
    ds_read_b32 v22, v10
    s_sub_u32 s72, s55, s56
    s_cmp_ge_u32 s72, 4
    s_cbranch_scc1 K2_g3_p3
    s_cmp_ge_u32 s72, 3
    s_cbranch_scc1 K2_g3_p2
    s_cmp_ge_u32 s72, 2
    s_cbranch_scc1 K2_g3_p1
    s_setprio 0
    s_branch K2_g3_pd
K2_g3_p1:
    s_setprio 1
    s_branch K2_g3_pd
K2_g3_p2:
    s_setprio 2
    s_branch K2_g3_pd
K2_g3_p3:
    s_setprio 3
K2_g3_pd:
    s_waitcnt lgkmcnt(9)
    v_mfma_f32_32x32x16_bf16 v[56:71], v[84:87], v[16:19], 0
    s_waitcnt lgkmcnt(8)
    v_mfma_f32_32x32x16_bf16 v[56:71], v[80:83], v[28:31], v[56:71]
    s_waitcnt lgkmcnt(6)
    v_mfma_f32_32x32x16_bf16 v[56:71], v[72:75], v[32:35], v[56:71]
    v_mfma_f32_32x32x16_bf16 v[56:71], v[76:79], v[36:39], v[56:71]
    s_add_u32 s72, s56, 1
    v_add_u32 v9, 2560, v9
    v_add_u32 v10, 2560, v10
    v_add_u32 v7, 2560, v7
    v_add_u32 v8, 2560, v8
    s_waitcnt lgkmcnt(0)
    s_cmp_ge_u32 s72, s55
    s_cbranch_scc1 K2_g3_last
    v_add_u32 v20, v20, v12
    v_add_u32 v21, v21, v12
    s_mov_b32 m0, s43
    v_lshrrev_b32 v22, 3, v22
    buffer_load_dwordx4 v20, s[8:11], s44 offen lds
    s_mov_b32 m0, s84
    v_add_u32 v22, v22, v6
    buffer_load_dwordx4 v21, s[8:11], s44 offen lds
    s_mov_b32 m0, s85
    s_nop 0
    buffer_load_dwordx4 v22, s[12:15], 0 offen lds
K2_g3_nodma:
    s_nop 3
    v_exp_f32 v88, -v56
    v_exp_f32 v89, -v57
    v_exp_f32 v90, -v58
    v_exp_f32 v91, -v59
    v_exp_f32 v92, -v60
    v_exp_f32 v93, -v61
    v_exp_f32 v94, -v62
    v_exp_f32 v95, -v63
    v_pk_add_f32 v[88:89], v[88:89], s[40:41]
    v_pk_add_f32 v[90:91], v[90:91], s[40:41]
    v_pk_add_f32 v[92:93], v[92:93], s[40:41]
    v_pk_add_f32 v[94:95], v[94:95], s[40:41]
    v_rcp_f32 v88, v88
    v_rcp_f32 v89, v89
    v_rcp_f32 v90, v90
    v_rcp_f32 v91, v91
    v_rcp_f32 v92, v92
    v_rcp_f32 v93, v93
    v_rcp_f32 v94, v94
    v_rcp_f32 v95, v95
    v_pk_mul_f32 v[88:89], v[88:89], v[56:57]
    v_pk_mul_f32 v[90:91], v[90:91], v[58:59]
    v_pk_mul_f32 v[92:93], v[92:93], v[60:61]
    v_pk_mul_f32 v[94:95], v[94:95], v[62:63]
    v_cvt_pk_bf16_f32 v104, v88, v89
    v_cvt_pk_bf16_f32 v105, v90, v91
    v_cvt_pk_bf16_f32 v106, v92, v93
    v_cvt_pk_bf16_f32 v107, v94, v95
    s_waitcnt lgkmcnt(0)
    s_cmp_eq_u32 s58, 0
    s_cbranch_scc1 K2_g3_acc
    v_mfma_f32_32x32x16_bf16 v[40:55], v[104:107], v[112:115], 0
    s_mov_b32 s58, 0
    s_branch K2_g3_acc2
K2_g3_acc:
    v_mfma_f32_32x32x16_bf16 v[40:55], v[104:107], v[112:115], v[40:55]
K2_g3_acc2:
    s_cmp_eq_u32 s56, s59
    s_cbranch_scc1 K2_g3_skip2
    v_exp_f32 v96, -v64
    v_exp_f32 v97, -v65
    v_exp_f32 v98, -v66
    v_exp_f32 v99, -v67
    v_exp_f32 v100, -v68
    v_exp_f32 v101, -v69
    v_exp_f32 v102, -v70
    v_exp_f32 v103, -v71
    v_pk_add_f32 v[96:97], v[96:97], s[40:41]
    v_pk_add_f32 v[98:99], v[98:99], s[40:41]
    v_pk_add_f32 v[100:101], v[100:101], s[40:41]
    v_pk_add_f32 v[102:103], v[102:103], s[40:41]
    v_rcp_f32 v96, v96
    v_rcp_f32 v97, v97
    v_rcp_f32 v98, v98
    v_rcp_f32 v99, v99
    v_rcp_f32 v100, v100
    v_rcp_f32 v101, v101
    v_rcp_f32 v102, v102
    v_rcp_f32 v103, v103
    v_pk_mul_f32 v[96:97], v[96:97], v[64:65]
    v_pk_mul_f32 v[98:99], v[98:99], v[66:67]
    v_pk_mul_f32 v[100:101], v[100:101], v[68:69]
    v_pk_mul_f32 v[102:103], v[102:103], v[70:71]
    v_cvt_pk_bf16_f32 v108, v96, v97
    v_cvt_pk_bf16_f32 v109, v98, v99
    v_cvt_pk_bf16_f32 v110, v100, v101
    v_cvt_pk_bf16_f32 v111, v102, v103
    s_nop 1
    v_mfma_f32_32x32x16_bf16 v[40:55], v[108:111], v[116:119], v[40:55]
K2_g3_skip2:
    s_add_u32 s56, s56, 1
    s_cmp_lt_u32 s56, s57
    s_cbranch_scc1 K2_g3_loop
    v_and_b32 v23, 16, v15
    s_lshl_b32 s72, s37, 7
    s_add_u32 s72, s72, 128
    v_add_u32 v23, s72, v23
    ds_read_b128 v[88:91], v23 offset:0
    ds_read_b128 v[92:95], v23 offset:32
    ds_read_b128 v[96:99], v23 offset:64
    ds_read_b128 v[100:103], v23 offset:96
    s_cmp_lg_u32 s42, 0
    s_cbranch_scc1 K2_g3_sflush
    s_nop 7
    v_cvt_pk_bf16_f32 v104, v40, v41
    v_cvt_pk_bf16_f32 v105, v42, v43
    v_cvt_pk_bf16_f32 v106, v44, v45
    v_cvt_pk_bf16_f32 v107, v46, v47
    v_cvt_pk_bf16_f32 v108, v48, v49
    v_cvt_pk_bf16_f32 v109, v50, v51
    v_cvt_pk_bf16_f32 v110, v52, v53
    v_cvt_pk_bf16_f32 v111, v54, v55
    s_mov_b32 exec_lo, 0xff
    s_mov_b32 exec_hi, 0xff
    ds_write_b64 v14, v[104:105] offset:6528
    ds_write_b64 v14, v[106:107] offset:6544
    ds_write_b64 v14, v[108:109] offset:6560
    ds_write_b64 v14, v[110:111] offset:6576
    s_mov_b64 exec, -1
    s_waitcnt lgkmcnt(4)
    v_pk_mul_f32 v[112:113], v[40:41], v[88:89]
    v_pk_fma_f32 v[112:113], v[42:43], v[90:91], v[112:113]
    v_pk_fma_f32 v[112:113], v[44:45], v[92:93], v[112:113]
    v_pk_fma_f32 v[112:113], v[46:47], v[94:95], v[112:113]
    v_pk_fma_f32 v[112:113], v[48:49], v[96:97], v[112:113]
    v_pk_fma_f32 v[112:113], v[50:51], v[98:99], v[112:113]
    v_pk_fma_f32 v[112:113], v[52:53], v[100:101], v[112:113]
    v_pk_fma_f32 v[112:113], v[54:55], v[102:103], v[112:113]
    v_add_f32 v112, v112, v113
    ds_write_b32 v15, v112 offset:3072
    s_cmp_lg_u32 s37, 0
    s_cbranch_scc1 K2_g3_done
    s_lshl_b32 s72, s38, 2
    v_mov_b32 v23, s72
    v_mov_b32 v24, 4
    s_mov_b64 exec, 1
    ds_write_b32 v23, v24 offset:44
    s_mov_b64 exec, -1
K2_g3_done:
K2_g4:
    s_min_u32 s57, s55, s51
    s_cmp_ge_u32 s56, s57
    s_cbranch_scc1 K2_g4_done
    v_mad_u32_u24 v23, v11, 4, v13
    ds_read_b128 v[16:19], v23
    s_sub_u32 s59, s51, 1
    s_bitcmp1_b32 s52, 4
    s_cselect_b32 s59, s59, -1
    s_mov_b32 s58, 1
K2_g4_loop:
    ds_read_b128 v[84:87], v7
    s_waitcnt vmcnt(0)
    ds_read_b128 v[80:83], v5
    v_mov_b32 v5, v26
    ds_read_b128 v[72:75], v4
    ds_read_b128 v[76:79], v1
    ds_read_b64_tr_b16 v[112:113], v8 offset:0
    ds_read_b64_tr_b16 v[114:115], v8 offset:512
    ds_read_b64_tr_b16 v[116:117], v8 offset:1024
    ds_read_b64_tr_b16 v[118:119], v8 offset:1536
    ds_read2_b32 v[20:21], v9 offset0:0 offset1:64
    ds_read_b32 v22, v10
    s_sub_u32 s72, s55, s56
    s_cmp_ge_u32 s72, 4
    s_cbranch_scc1 K2_g4_p3
    s_cmp_ge_u32 s72, 3
    s_cbranch_scc1 K2_g4_p2
    s_cmp_ge_u32 s72, 2
    s_cbranch_scc1 K2_g4_p1
    s_setprio 0
    s_branch K2_g4_pd
K2_g4_p1:
    s_setprio 1
    s_branch K2_g4_pd
K2_g4_p2:
    s_setprio 2
    s_branch K2_g4_pd
K2_g4_p3:
    s_setprio 3
K2_g4_pd:
    s_waitcnt lgkmcnt(9)
    v_mfma_f32_32x32x16_bf16 v[56:71], v[84:87], v[16:19], 0
    s_waitcnt lgkmcnt(8)
    v_mfma_f32_32x32x16_bf16 v[56:71], v[80:83], v[28:31], v[56:71]
    s_waitcnt lgkmcnt(6)
    v_mfma_f32_32x32x16_bf16 v[56:71], v[72:75], v[32:35], v[56:71]
    v_mfma_f32_32x32x16_bf16 v[56:71], v[76:79], v[36:39], v[56:71]
    s_add_u32 s72, s56, 1
    v_add_u32 v9, 2560, v9
    v_add_u32 v10, 2560, v10
    v_add_u32 v7, 2560, v7
    v_add_u32 v8, 2560, v8
    s_waitcnt lgkmcnt(0)
    s_cmp_ge_u32 s72, s55
    s_cbranch_scc1 K2_g4_last
    v_add_u32 v20, v20, v12
    v_add_u32 v21, v21, v12
    s_mov_b32 m0, s43
    v_lshrrev_b32 v22, 3, v22
    buffer_load_dwordx4 v20, s[8:11], s44 offen lds
    s_mov_b32 m0, s84
    v_add_u32 v22, v22, v6
    buffer_load_dwordx4 v21, s[8:11], s44 offen lds
    s_mov_b32 m0, s85
    s_nop 0
    buffer_load_dwordx4 v22, s[12:15], 0 offen lds
K2_g4_nodma:
    s_nop 3
    v_exp_f32 v88, -v56
    v_exp_f32 v89, -v57
    v_exp_f32 v90, -v58
    v_exp_f32 v91, -v59
    v_exp_f32 v92, -v60
    v_exp_f32 v93, -v61
    v_exp_f32 v94, -v62
    v_exp_f32 v95, -v63
    v_pk_add_f32 v[88:89], v[88:89], s[40:41]
    v_pk_add_f32 v[90:91], v[90:91], s[40:41]
    v_pk_add_f32 v[92:93], v[92:93], s[40:41]
    v_pk_add_f32 v[94:95], v[94:95], s[40:41]
    v_rcp_f32 v88, v88
    v_rcp_f32 v89, v89
    v_rcp_f32 v90, v90
    v_rcp_f32 v91, v91
    v_rcp_f32 v92, v92
    v_rcp_f32 v93, v93
    v_rcp_f32 v94, v94
    v_rcp_f32 v95, v95
    v_pk_mul_f32 v[88:89], v[88:89], v[56:57]
    v_pk_mul_f32 v[90:91], v[90:91], v[58:59]
    v_pk_mul_f32 v[92:93], v[92:93], v[60:61]
    v_pk_mul_f32 v[94:95], v[94:95], v[62:63]
    v_cvt_pk_bf16_f32 v104, v88, v89
    v_cvt_pk_bf16_f32 v105, v90, v91
    v_cvt_pk_bf16_f32 v106, v92, v93
    v_cvt_pk_bf16_f32 v107, v94, v95
    s_waitcnt lgkmcnt(0)
    s_cmp_eq_u32 s58, 0
    s_cbranch_scc1 K2_g4_acc
    v_mfma_f32_32x32x16_bf16 v[40:55], v[104:107], v[112:115], 0
    s_mov_b32 s58, 0
    s_branch K2_g4_acc2
K2_g4_acc:
    v_mfma_f32_32x32x16_bf16 v[40:55], v[104:107], v[112:115], v[40:55]
K2_g4_acc2:
    s_cmp_eq_u32 s56, s59
    s_cbranch_scc1 K2_g4_skip2
    v_exp_f32 v96, -v64
    v_exp_f32 v97, -v65
    v_exp_f32 v98, -v66
    v_exp_f32 v99, -v67
    v_exp_f32 v100, -v68
    v_exp_f32 v101, -v69
    v_exp_f32 v102, -v70
    v_exp_f32 v103, -v71
    v_pk_add_f32 v[96:97], v[96:97], s[40:41]
    v_pk_add_f32 v[98:99], v[98:99], s[40:41]
    v_pk_add_f32 v[100:101], v[100:101], s[40:41]
    v_pk_add_f32 v[102:103], v[102:103], s[40:41]
    v_rcp_f32 v96, v96
    v_rcp_f32 v97, v97
    v_rcp_f32 v98, v98
    v_rcp_f32 v99, v99
    v_rcp_f32 v100, v100
    v_rcp_f32 v101, v101
    v_rcp_f32 v102, v102
    v_rcp_f32 v103, v103
    v_pk_mul_f32 v[96:97], v[96:97], v[64:65]
    v_pk_mul_f32 v[98:99], v[98:99], v[66:67]
    v_pk_mul_f32 v[100:101], v[100:101], v[68:69]
    v_pk_mul_f32 v[102:103], v[102:103], v[70:71]
    v_cvt_pk_bf16_f32 v108, v96, v97
    v_cvt_pk_bf16_f32 v109, v98, v99
    v_cvt_pk_bf16_f32 v110, v100, v101
    v_cvt_pk_bf16_f32 v111, v102, v103
    s_nop 1
    v_mfma_f32_32x32x16_bf16 v[40:55], v[108:111], v[116:119], v[40:55]
K2_g4_skip2:
    s_add_u32 s56, s56, 1
    s_cmp_lt_u32 s56, s57
    s_cbranch_scc1 K2_g4_loop
    v_and_b32 v23, 16, v15
    s_lshl_b32 s72, s37, 7
    s_add_u32 s72, s72, 128
    v_add_u32 v23, s72, v23
    ds_read_b128 v[88:91], v23 offset:0
    ds_read_b128 v[92:95], v23 offset:32
    ds_read_b128 v[96:99], v23 offset:64
    ds_read_b128 v[100:103], v23 offset:96
    s_cmp_lg_u32 s42, 0
    s_cbranch_scc1 K2_g4_sflush
    s_nop 7
    v_cvt_pk_bf16_f32 v104, v40, v41
    v_cvt_pk_bf16_f32 v105, v42, v43
    v_cvt_pk_bf16_f32 v106, v44, v45
    v_cvt_pk_bf16_f32 v107, v46, v47
    v_cvt_pk_bf16_f32 v108, v48, v49
    v_cvt_pk_bf16_f32 v109, v50, v51
    v_cvt_pk_bf16_f32 v110, v52, v53
    v_cvt_pk_bf16_f32 v111, v54, v55
    s_mov_b32 exec_lo, 0xff
    s_mov_b32 exec_hi, 0xff
    ds_write_b64 v14, v[104:105] offset:8704
    ds_write_b64 v14, v[106:107] offset:8720
    ds_write_b64 v14, v[108:109] offset:8736
    ds_write_b64 v14, v[110:111] offset:8752
    s_mov_b64 exec, -1
    s_waitcnt lgkmcnt(4)
    v_pk_mul_f32 v[112:113], v[40:41], v[88:89]
    v_pk_fma_f32 v[112:113], v[42:43], v[90:91], v[112:113]
    v_pk_fma_f32 v[112:113], v[44:45], v[92:93], v[112:113]
    v_pk_fma_f32 v[112:113], v[46:47], v[94:95], v[112:113]
    v_pk_fma_f32 v[112:113], v[48:49], v[96:97], v[112:113]
    v_pk_fma_f32 v[112:113], v[50:51], v[98:99], v[112:113]
    v_pk_fma_f32 v[112:113], v[52:53], v[100:101], v[112:113]
    v_pk_fma_f32 v[112:113], v[54:55], v[102:103], v[112:113]
    v_add_f32 v112, v112, v113
    ds_write_b32 v15, v112 offset:4096
    s_cmp_lg_u32 s37, 0
    s_cbranch_scc1 K2_g4_done
    s_lshl_b32 s72, s38, 2
    v_mov_b32 v23, s72
    v_mov_b32 v24, 5
    s_mov_b64 exec, 1
    ds_write_b32 v23, v24 offset:48
    s_mov_b64 exec, -1
K2_g4_done:
K2_mainend:
    s_setprio 0
    s_cmp_eq_u32 s42, 0
    s_cbranch_scc1 K2_epi
    s_add_u32 s42, s42, 1
    s_cmp_gt_u32 s42, 250
    s_cbranch_scc1 K2_slowend
    s_waitcnt vmcnt(0) lgkmcnt(0)
    s_barrier
    s_branch K2_batch
K2_epi:
    v_and_b32 v4, 63, v0
    s_mov_b32 s73, s93
    s_bitcmp1_b32 s38, 0
    s_cbranch_scc1 K2_e0
    s_cmp_lg_u32 s88, 0
    s_cbranch_scc1 K2_e0
    s_waitcnt vmcnt(0)
    v_and_b32 v23, 63, v0
    v_lshlrev_b32 v23, 4, v23
    s_lshl_b32 s3, s37, 13
    s_add_u32 s3, s3, 10518528
    s_add_u32 s72, s3, 4096
    buffer_load_dwordx4 v[72:75], v23, s[8:11], s3 offen offset:0
    buffer_load_dwordx4 v[76:79], v23, s[8:11], s3 offen offset:1024
    buffer_load_dwordx4 v[80:83], v23, s[8:11], s3 offen offset:2048
    buffer_load_dwordx4 v[84:87], v23, s[8:11], s3 offen offset:3072
    buffer_load_dwordx4 v[120:123], v23, s[8:11], s72 offen offset:0
    buffer_load_dwordx4 v[124:127], v23, s[8:11], s72 offen offset:1024
    buffer_load_dwordx4 v[16:19], v23, s[8:11], s72 offen offset:2048
    buffer_load_dwordx4 v[28:31], v23, s[8:11], s72 offen offset:3072
K2_e0:
    v_lshlrev_b32 v2, 4, v0
    v_mov_b32 v3, 0x7fffff00
    v_cmp_gt_u32 vcc, 640, v0
    s_nop 1
    v_cndmask_b32 v2, v3, v2, vcc
    v_subrev_u32 v7, 640, v0
    v_lshlrev_b32 v6, 1, v7
    v_cmp_gt_u32 vcc, 120, v7
    s_nop 1
    v_cndmask_b32 v6, v3, v6, vcc
    s_cmp_ge_u32 s36, 12
    s_cbranch_scc1 K2_e00
    s_cmp_ge_u32 s36, 10
    s_cbranch_scc1 K2_e0p
    buffer_load_dwordx4 v[32:35], v2, s[20:23], s73 offen
    s_add_u32 s72, s73, 7340032
    buffer_load_dwordx4 v[36:39], v2, s[8:11], s72 offen
    s_branch K2_e00
K2_e0p:
    buffer_load_ushort v39, v6, s[32:35], s45 offen
K2_e00:
    s_waitcnt lgkmcnt(0)
    s_barrier
    s_bitcmp1_b32 s38, 0
    s_cbranch_scc1 K2_e1
    v_and_b32 v24, 31, v4
    v_lshrrev_b32 v25, 5, v4
    s_lshr_b32 s72, s38, 1
    v_mul_u32_u24 v27, 272, v24
    v_lshl_add_u32 v27, v25, 4, v27
    s_mul_i32 s3, s72, 8704
    s_add_u32 s3, s3, 121856
    v_add_u32 v27, s3, v27
    ds_read_b128 v[88:91], v27 offset:0
    ds_read_b128 v[92:95], v27 offset:32
    ds_read_b128 v[96:99], v27 offset:64
    ds_read_b128 v[100:103], v27 offset:96
    ds_read_b128 v[104:107], v27 offset:128
    ds_read_b128 v[108:111], v27 offset:160
    ds_read_b128 v[112:115], v27 offset:192
    ds_read_b128 v[116:119], v27 offset:224
    v_mul_u32_u24 v26, 2112, v25
    v_lshl_add_u32 v26, v24, 2, v26
    s_mul_i32 s3, s72, 16896
    s_lshl_b32 s72, s37, 7
    s_add_u32 s3, s3, s72
    s_add_u32 s3, s3, 1024
    v_add_u32 v26, s3, v26
    s_waitcnt vmcnt(1) lgkmcnt(0)
    v_mfma_f32_32x32x16_bf16 v[40:55], v[88:91], v[72:75], 0
    v_mfma_f32_32x32x16_bf16 v[40:55], v[92:95], v[76:79], v[40:55]
    v_mfma_f32_32x32x16_bf16 v[40:55], v[96:99], v[80:83], v[40:55]
    v_mfma_f32_32x32x16_bf16 v[40:55], v[100:103], v[84:87], v[40:55]
    v_mfma_f32_32x32x16_bf16 v[40:55], v[104:107], v[120:123], v[40:55]
    v_mfma_f32_32x32x16_bf16 v[40:55], v[108:111], v[124:127], v[40:55]
    v_mfma_f32_32x32x16_bf16 v[40:55], v[112:115], v[16:19], v[40:55]
    v_mfma_f32_32x32x16_bf16 v[40:55], v[116:119], v[28:31], v[40:55]
    s_nop 11
    ds_write_b32 v26, v40 offset:0
    ds_write_b32 v26, v41 offset:528
    ds_write_b32 v26, v42 offset:1056
    ds_write_b32 v26, v43 offset:1584
    ds_write_b32 v26, v44 offset:4224
    ds_write_b32 v26, v45 offset:4752
    ds_write_b32 v26, v46 offset:5280
    ds_write_b32 v26, v47 offset:5808
    ds_write_b32 v26, v48 offset:8448
    ds_write_b32 v26, v49 offset:8976
    ds_write_b32 v26, v50 offset:9504
    ds_write_b32 v26, v51 offset:10032
    ds_write_b32 v26, v52 offset:12672
    ds_write_b32 v26, v53 offset:13200
    ds_write_b32 v26, v54 offset:13728
    ds_write_b32 v26, v55 offset:14256
K2_e1:
    s_waitcnt lgkmcnt(0)
    s_barrier
    s_cmp_ge_u32 s36, 12
    s_cbranch_scc1 K2_end
    s_cmp_ge_u32 s36, 10
    s_cbranch_scc1 K2_e_pos
    s_lshr_b32 s3, s36, 1
    s_lshl_b32 s72, s3, 2
    v_mov_b32 v8, s72
    ds_read2_b32 v[10:11], v8 offset0:8 offset1:9
    ds_read2_b32 v[12:13], v8 offset0:10 offset1:11
    v_lshrrev_b32 v5, 4, v0
    v_and_b32 v5, 7, v5
    v_and_b32 v6, 15, v0
    v_mul_u32_u24 v5, 528, v5
    v_lshl_add_u32 v5, v6, 5, v5
    s_mul_i32 s72, s3, 4224
    s_add_u32 s72, s72, 1024
    v_add_u32 v5, s72, v5
    s_add_u32 s3, s3, 1
    s_waitcnt vmcnt(0)
    v_lshlrev_b32 v40, 16, v36
    v_and_b32 v41, 0xffff0000, v36
    v_lshlrev_b32 v42, 16, v37
    v_and_b32 v43, 0xffff0000, v37
    v_lshlrev_b32 v44, 16, v38
    v_and_b32 v45, 0xffff0000, v38
    v_lshlrev_b32 v46, 16, v39
    v_and_b32 v47, 0xffff0000, v39
    s_waitcnt lgkmcnt(0)
    v_readfirstlane_b32 s72, v10
    s_nop 0
    s_cmp_lg_u32 s72, s3
    s_cbranch_scc1 K2_f0
    ds_read_b128 v[48:51], v5 offset:0
    ds_read_b128 v[52:55], v5 offset:16
    s_waitcnt lgkmcnt(0)
    v_pk_add_f32 v[40:41], v[40:41], v[48:49]
    v_pk_add_f32 v[42:43], v[42:43], v[50:51]
    v_pk_add_f32 v[44:45], v[44:45], v[52:53]
    v_pk_add_f32 v[46:47], v[46:47], v[54:55]
K2_f0:
    v_readfirstlane_b32 s72, v11
    s_nop 0
    s_cmp_lg_u32 s72, s3
    s_cbranch_scc1 K2_f1
    ds_read_b128 v[48:51], v5 offset:4224
    ds_read_b128 v[52:55], v5 offset:4240
    s_waitcnt lgkmcnt(0)
    v_pk_add_f32 v[40:41], v[40:41], v[48:49]
    v_pk_add_f32 v[42:43], v[42:43], v[50:51]
    v_pk_add_f32 v[44:45], v[44:45], v[52:53]
    v_pk_add_f32 v[46:47], v[46:47], v[54:55]
K2_f1:
    v_readfirstlane_b32 s72, v12
    s_nop 0
    s_cmp_lg_u32 s72, s3
    s_cbranch_scc1 K2_f2
    ds_read_b128 v[48:51], v5 offset:8448
    ds_read_b128 v[52:55], v5 offset:8464
    s_waitcnt lgkmcnt(0)
    v_pk_add_f32 v[40:41], v[40:41], v[48:49]
    v_pk_add_f32 v[42:43], v[42:43], v[50:51]
    v_pk_add_f32 v[44:45], v[44:45], v[52:53]
    v_pk_add_f32 v[46:47], v[46:47], v[54:55]
K2_f2:
    v_readfirstlane_b32 s72, v13
    s_nop 0
    s_cmp_lg_u32 s72, s3
    s_cbranch_scc1 K2_f3
    ds_read_b128 v[48:51], v5 offset:12672
    ds_read_b128 v[52:55], v5 offset:12688
    s_waitcnt lgkmcnt(0)
    v_pk_add_f32 v[40:41], v[40:41], v[48:49]
    v_pk_add_f32 v[42:43], v[42:43], v[50:51]
    v_pk_add_f32 v[44:45], v[44:45], v[52:53]
    v_pk_add_f32 v[46:47], v[46:47], v[54:55]
K2_f3:
    v_exp_f32 v48, -v40
    v_exp_f32 v49, -v41
    v_exp_f32 v50, -v42
    v_exp_f32 v51, -v43
    v_exp_f32 v52, -v44
    v_exp_f32 v53, -v45
    v_exp_f32 v54, -v46
    v_exp_f32 v55, -v47
    v_lshlrev_b32 v56, 16, v32
    v_and_b32 v57, 0xffff0000, v32
    v_lshlrev_b32 v58, 16, v33
    v_and_b32 v59, 0xffff0000, v33
    v_lshlrev_b32 v60, 16, v34
    v_and_b32 v61, 0xffff0000, v34
    v_lshlrev_b32 v62, 16, v35
    v_and_b32 v63, 0xffff0000, v35
    v_pk_add_f32 v[48:49], v[48:49], s[40:41]
    v_pk_add_f32 v[50:51], v[50:51], s[40:41]
    v_pk_add_f32 v[52:53], v[52:53], s[40:41]
    v_pk_add_f32 v[54:55], v[54:55], s[40:41]
    v_rcp_f32 v48, v48
    v_rcp_f32 v49, v49
    v_rcp_f32 v50, v50
    v_rcp_f32 v51, v51
    v_rcp_f32 v52, v52
    v_rcp_f32 v53, v53
    v_rcp_f32 v54, v54
    v_rcp_f32 v55, v55
    v_mov_b32 v64, s60
    v_mov_b32 v65, s60
    v_pk_mul_f32 v[40:41], v[40:41], v[48:49]
    v_pk_mul_f32 v[42:43], v[42:43], v[50:51]
    v_pk_mul_f32 v[44:45], v[44:45], v[52:53]
    v_pk_mul_f32 v[46:47], v[46:47], v[54:55]
    v_pk_fma_f32 v[40:41], v[40:41], v[64:65], v[56:57]
    v_pk_fma_f32 v[42:43], v[42:43], v[64:65], v[58:59]
    v_pk_fma_f32 v[44:45], v[44:45], v[64:65], v[60:61]
    v_pk_fma_f32 v[46:47], v[46:47], v[64:65], v[62:63]
    v_cvt_pk_bf16_f32 v48, v40, v41
    v_cvt_pk_bf16_f32 v49, v42, v43
    v_cvt_pk_bf16_f32 v50, v44, v45
    v_cvt_pk_bf16_f32 v51, v46, v47
    buffer_store_dwordx4 v[48:51], v2, s[16:19], s73 offen
    s_endpgm
K2_e_pos:
    v_cmp_gt_u32 vcc, 120, v7
    s_nop 0
    s_and_saveexec_b64 s[76:77], vcc
    s_cbranch_execz K2_end
    v_mul_u32_u24 v8, 43691, v7
    v_lshrrev_b32 v8, 17, v8
    v_mul_u32_u24 v9, 3, v8
    v_sub_u32 v9, v7, v9
    v_lshrrev_b32 v10, 3, v8
    v_and_b32 v11, 7, v8
    v_add_u32 v9, 1, v9
    v_lshl_add_u32 v9, v9, 3, v11
    v_lshlrev_b32 v9, 5, v9
    v_lshl_add_u32 v9, v10, 10, v9
    v_add_u32 v9, 139264, v9
    v_lshlrev_b32 v12, 2, v10
    v_add_u32 v10, 1, v10
    v_mov_b32 v13, 0
    ds_read_b32 v14, v12 offset:32
    ds_read_b128 v[16:19], v9 offset:0
    ds_read_b128 v[20:23], v9 offset:16
    s_waitcnt lgkmcnt(0)
    v_add_f32 v16, v16, v17
    v_add_f32 v18, v18, v19
    v_add_f32 v20, v20, v21
    v_add_f32 v22, v22, v23
    v_add_f32 v16, v16, v18
    v_add_f32 v20, v20, v22
    v_add_f32 v16, v16, v20
    v_cmp_eq_u32 vcc, v14, v10
    s_nop 1
    v_cndmask_b32 v16, 0, v16, vcc
    v_add_f32 v13, v13, v16
    ds_read_b32 v14, v12 offset:36
    ds_read_b128 v[16:19], v9 offset:1024
    ds_read_b128 v[20:23], v9 offset:1040
    s_waitcnt lgkmcnt(0)
    v_add_f32 v16, v16, v17
    v_add_f32 v18, v18, v19
    v_add_f32 v20, v20, v21
    v_add_f32 v22, v22, v23
    v_add_f32 v16, v16, v18
    v_add_f32 v20, v20, v22
    v_add_f32 v16, v16, v20
    v_cmp_eq_u32 vcc, v14, v10
    s_nop 1
    v_cndmask_b32 v16, 0, v16, vcc
    v_add_f32 v13, v13, v16
    ds_read_b32 v14, v12 offset:40
    ds_read_b128 v[16:19], v9 offset:2048
    ds_read_b128 v[20:23], v9 offset:2064
    s_waitcnt lgkmcnt(0)
    v_add_f32 v16, v16, v17
    v_add_f32 v18, v18, v19
    v_add_f32 v20, v20, v21
    v_add_f32 v22, v22, v23
    v_add_f32 v16, v16, v18
    v_add_f32 v20, v20, v22
    v_add_f32 v16, v16, v20
    v_cmp_eq_u32 vcc, v14, v10
    s_nop 1
    v_cndmask_b32 v16, 0, v16, vcc
    v_add_f32 v13, v13, v16
    ds_read_b32 v14, v12 offset:44
    ds_read_b128 v[16:19], v9 offset:3072
    ds_read_b128 v[20:23], v9 offset:3088
    s_waitcnt lgkmcnt(0)
    v_add_f32 v16, v16, v17
    v_add_f32 v18, v18, v19
    v_add_f32 v20, v20, v21
    v_add_f32 v22, v22, v23
    v_add_f32 v16, v16, v18
    v_add_f32 v20, v20, v22
    v_add_f32 v16, v16, v20
    v_cmp_eq_u32 vcc, v14, v10
    s_nop 1
    v_cndmask_b32 v16, 0, v16, vcc
    v_add_f32 v13, v13, v16
    s_waitcnt vmcnt(0)
    v_lshlrev_b32 v39, 16, v39
    v_add_f32 v13, v13, v39
    v_cvt_pk_bf16_f32 v13, v13, v13
    s_add_u32 s3, s45, 2560000
    buffer_store_short v13, v6, s[16:19], s3 offen
    s_endpgm
K2_end:
    s_endpgm
K2_g0_last:
    s_bitcmp1_b32 s38, 0
    s_cbranch_scc1 K2_g0_lastd
    s_cmp_lg_u32 s42, 0
    s_cbranch_scc1 K2_g0_lastd
    v_and_b32 v23, 63, v0
    v_lshlrev_b32 v23, 4, v23
    s_lshl_b32 s3, s37, 13
    s_add_u32 s3, s3, 10518528
    s_add_u32 s72, s3, 4096
    buffer_load_dwordx4 v[72:75], v23, s[8:11], s3 offen offset:0
    buffer_load_dwordx4 v[76:79], v23, s[8:11], s3 offen offset:1024
    buffer_load_dwordx4 v[80:83], v23, s[8:11], s3 offen offset:2048
    buffer_load_dwordx4 v[84:87], v23, s[8:11], s3 offen offset:3072
    buffer_load_dwordx4 v[120:123], v23, s[8:11], s72 offen offset:0
    buffer_load_dwordx4 v[124:127], v23, s[8:11], s72 offen offset:1024
    buffer_load_dwordx4 v[16:19], v23, s[8:11], s72 offen offset:2048
    buffer_load_dwordx4 v[28:31], v23, s[8:11], s72 offen offset:3072
    s_mov_b32 s88, 1
K2_g0_lastd:
    s_nop 3
    s_branch K2_g0_nodma
K2_g1_last:
    s_bitcmp1_b32 s38, 0
    s_cbranch_scc1 K2_g1_lastd
    s_cmp_lg_u32 s42, 0
    s_cbranch_scc1 K2_g1_lastd
    v_and_b32 v23, 63, v0
    v_lshlrev_b32 v23, 4, v23
    s_lshl_b32 s3, s37, 13
    s_add_u32 s3, s3, 10518528
    s_add_u32 s72, s3, 4096
    buffer_load_dwordx4 v[72:75], v23, s[8:11], s3 offen offset:0
    buffer_load_dwordx4 v[76:79], v23, s[8:11], s3 offen offset:1024
    buffer_load_dwordx4 v[80:83], v23, s[8:11], s3 offen offset:2048
    buffer_load_dwordx4 v[84:87], v23, s[8:11], s3 offen offset:3072
    buffer_load_dwordx4 v[120:123], v23, s[8:11], s72 offen offset:0
    buffer_load_dwordx4 v[124:127], v23, s[8:11], s72 offen offset:1024
    buffer_load_dwordx4 v[16:19], v23, s[8:11], s72 offen offset:2048
    buffer_load_dwordx4 v[28:31], v23, s[8:11], s72 offen offset:3072
    s_mov_b32 s88, 1
K2_g1_lastd:
    s_nop 3
    s_branch K2_g1_nodma
K2_g2_last:
    s_bitcmp1_b32 s38, 0
    s_cbranch_scc1 K2_g2_lastd
    s_cmp_lg_u32 s42, 0
    s_cbranch_scc1 K2_g2_lastd
    v_and_b32 v23, 63, v0
    v_lshlrev_b32 v23, 4, v23
    s_lshl_b32 s3, s37, 13
    s_add_u32 s3, s3, 10518528
    s_add_u32 s72, s3, 4096
    buffer_load_dwordx4 v[72:75], v23, s[8:11], s3 offen offset:0
    buffer_load_dwordx4 v[76:79], v23, s[8:11], s3 offen offset:1024
    buffer_load_dwordx4 v[80:83], v23, s[8:11], s3 offen offset:2048
    buffer_load_dwordx4 v[84:87], v23, s[8:11], s3 offen offset:3072
    buffer_load_dwordx4 v[120:123], v23, s[8:11], s72 offen offset:0
    buffer_load_dwordx4 v[124:127], v23, s[8:11], s72 offen offset:1024
    buffer_load_dwordx4 v[16:19], v23, s[8:11], s72 offen offset:2048
    buffer_load_dwordx4 v[28:31], v23, s[8:11], s72 offen offset:3072
    s_mov_b32 s88, 1
K2_g2_lastd:
    s_nop 3
    s_branch K2_g2_nodma
K2_g3_last:
    s_bitcmp1_b32 s38, 0
    s_cbranch_scc1 K2_g3_lastd
    s_cmp_lg_u32 s42, 0
    s_cbranch_scc1 K2_g3_lastd
    v_and_b32 v23, 63, v0
    v_lshlrev_b32 v23, 4, v23
    s_lshl_b32 s3, s37, 13
    s_add_u32 s3, s3, 10518528
    s_add_u32 s72, s3, 4096
    buffer_load_dwordx4 v[72:75], v23, s[8:11], s3 offen offset:0
    buffer_load_dwordx4 v[76:79], v23, s[8:11], s3 offen offset:1024
    buffer_load_dwordx4 v[80:83], v23, s[8:11], s3 offen offset:2048
    buffer_load_dwordx4 v[84:87], v23, s[8:11], s3 offen offset:3072
    buffer_load_dwordx4 v[120:123], v23, s[8:11], s72 offen offset:0
    buffer_load_dwordx4 v[124:127], v23, s[8:11], s72 offen offset:1024
    buffer_load_dwordx4 v[16:19], v23, s[8:11], s72 offen offset:2048
    buffer_load_dwordx4 v[28:31], v23, s[8:11], s72 offen offset:3072
    s_mov_b32 s88, 1
K2_g3_lastd:
    s_nop 3
    s_branch K2_g3_nodma
K2_g4_last:
    s_bitcmp1_b32 s38, 0
    s_cbranch_scc1 K2_g4_lastd
    s_cmp_lg_u32 s42, 0
    s_cbranch_scc1 K2_g4_lastd
    v_and_b32 v23, 63, v0
    v_lshlrev_b32 v23, 4, v23
    s_lshl_b32 s3, s37, 13
    s_add_u32 s3, s3, 10518528
    s_add_u32 s72, s3, 4096
    buffer_load_dwordx4 v[72:75], v23, s[8:11], s3 offen offset:0
    buffer_load_dwordx4 v[76:79], v23, s[8:11], s3 offen offset:1024
    buffer_load_dwordx4 v[80:83], v23, s[8:11], s3 offen offset:2048
    buffer_load_dwordx4 v[84:87], v23, s[8:11], s3 offen offset:3072
    buffer_load_dwordx4 v[120:123], v23, s[8:11], s72 offen offset:0
    buffer_load_dwordx4 v[124:127], v23, s[8:11], s72 offen offset:1024
    buffer_load_dwordx4 v[16:19], v23, s[8:11], s72 offen offset:2048
    buffer_load_dwordx4 v[28:31], v23, s[8:11], s72 offen offset:3072
    s_mov_b32 s88, 1
K2_g4_lastd:
    s_nop 3
    s_branch K2_g4_nodma
K2_toslow:
    s_mov_b32 s42, 1
    s_waitcnt vmcnt(0) lgkmcnt(0)
    s_barrier
    s_branch K2_batch
K2_slowzero:
    v_lshlrev_b32 v23, 4, v0
    v_add_u32 v23, 121856, v23
    v_mov_b32 v88, 0
    v_mov_b32 v89, 0
    v_mov_b32 v90, 0
    v_mov_b32 v91, 0
    ds_write_b128 v23, v[88:91]
    v_cmp_gt_u32 vcc, 336, v0
    s_nop 0
    s_and_saveexec_b64 s[76:77], vcc
    s_cbranch_execz K2_sz
    ds_write_b128 v23, v[88:91] offset:16384
K2_sz:
    s_mov_b64 exec, s[76:77]
    s_waitcnt lgkmcnt(0)
    s_barrier
    s_branch K2_zdone
K2_slowload:
    s_load_dwordx4 s[64:67], s[0:1], 24
    s_waitcnt lgkmcnt(0)
    s_mov_b32 s24, s64
    s_mov_b32 s25, s65
    s_mov_b32 s26, 640000
    s_mov_b32 s27, 0x20000
    s_mov_b32 s28, s66
    s_mov_b32 s29, s67
    s_mov_b32 s30, 640000
    s_mov_b32 s31, 0x20000
    s_sub_u32 s3, s42, 1
    s_mul_i32 s3, s3, 640
    v_add_u32 v68, s3, v0
    v_lshlrev_b32 v23, 2, v68
    v_mov_b32 v24, 0x7fffff00
    v_cmp_gt_u32 vcc, 640, v0
    s_nop 1
    v_cndmask_b32 v23, v24, v23, vcc
    buffer_load_dword v58, v23, s[28:31], 0 offen
    buffer_load_dword v59, v23, s[24:27], 0 offen
    s_mul_i32 s3, s39, 40
    v_mov_b32 v72, -1
    v_and_b32 v102, 7, v0
    v_lshlrev_b32 v102, 2, v102
    s_waitcnt vmcnt(0) lgkmcnt(0)
    s_barrier
    v_subrev_u32 v58, s3, v58
    v_lshl_or_b32 v56, v58, 14, v59
    v_cmp_gt_u32 s[78:79], 40, v58
    s_nop 0
    s_and_b64 s[78:79], s[78:79], vcc
    v_cndmask_b32 v56, -1, v56, s[78:79]
    s_branch K2_sort
K2_slowaddr:
    v_and_b32 v124, 63, v0
    v_and_b32 v92, 31, v124
    v_lshrrev_b32 v93, 5, v124
    v_lshlrev_b32 v95, 6, v92
    v_lshlrev_b32 v96, 4, v92
    v_add_u32 v96, 2048, v96
    v_cmp_eq_u32 vcc, 0, v93
    s_nop 1
    v_cndmask_b32 v95, v96, v95, vcc
    v_add_u32 v7, 1024, v95
    v_bfe_u32 v95, v124, 2, 2
    v_lshlrev_b32 v95, 6, v95
    v_lshl_add_u32 v95, v93, 8, v95
    v_and_b32 v96, 16, v124
    v_lshl_add_u32 v95, v96, 1, v95
    v_and_b32 v96, 3, v124
    v_lshl_add_u32 v95, v96, 3, v95
    v_add_u32 v8, 1024, v95
    v_lshrrev_b32 v95, 2, v124
    v_lshlrev_b32 v95, 4, v95
    v_add_u32 v9, 3076, v95
    v_lshrrev_b32 v95, 1, v124
    v_lshlrev_b32 v95, 4, v95
    v_add_u32 v10, 3080, v95
    s_branch K2_addr
K2_g0_sflush:
    s_waitcnt lgkmcnt(0)
    s_nop 7
    v_pk_mul_f32 v[112:113], v[40:41], v[88:89]
    v_pk_fma_f32 v[112:113], v[42:43], v[90:91], v[112:113]
    v_pk_fma_f32 v[112:113], v[44:45], v[92:93], v[112:113]
    v_pk_fma_f32 v[112:113], v[46:47], v[94:95], v[112:113]
    v_pk_fma_f32 v[112:113], v[48:49], v[96:97], v[112:113]
    v_pk_fma_f32 v[112:113], v[50:51], v[98:99], v[112:113]
    v_pk_fma_f32 v[112:113], v[52:53], v[100:101], v[112:113]
    v_pk_fma_f32 v[112:113], v[54:55], v[102:103], v[112:113]
    v_add_f32 v112, v112, v113
    v_and_b32 v23, 63, v0
    v_and_b32 v24, 7, v23
    v_bfe_u32 v25, v23, 3, 2
    v_lshlrev_b32 v25, 2, v25
    v_lshl_add_u32 v25, v24, 4, v25
    v_add_u32 v25, 142976, v25
    ds_add_f32 v25, v112
    v_mul_u32_u24 v24, 528, v24
    v_lshrrev_b32 v23, 5, v23
    v_lshl_add_u32 v24, v23, 4, v24
    s_lshl_b32 s72, s37, 7
    s_add_u32 s72, s72, 121856
    v_add_u32 v24, s72, v24
    s_mov_b32 exec_lo, 0xff
    s_mov_b32 exec_hi, 0xff
    ds_add_f32 v24, v40 offset:0
    ds_add_f32 v24, v41 offset:4
    ds_add_f32 v24, v42 offset:8
    ds_add_f32 v24, v43 offset:12
    ds_add_f32 v24, v44 offset:32
    ds_add_f32 v24, v45 offset:36
    ds_add_f32 v24, v46 offset:40
    ds_add_f32 v24, v47 offset:44
    ds_add_f32 v24, v48 offset:64
    ds_add_f32 v24, v49 offset:68
    ds_add_f32 v24, v50 offset:72
    ds_add_f32 v24, v51 offset:76
    ds_add_f32 v24, v52 offset:96
    ds_add_f32 v24, v53 offset:100
    ds_add_f32 v24, v54 offset:104
    ds_add_f32 v24, v55 offset:108
    s_mov_b64 exec, -1
    s_branch K2_g0_done
K2_g1_sflush:
    s_waitcnt lgkmcnt(0)
    s_nop 7
    v_pk_mul_f32 v[112:113], v[40:41], v[88:89]
    v_pk_fma_f32 v[112:113], v[42:43], v[90:91], v[112:113]
    v_pk_fma_f32 v[112:113], v[44:45], v[92:93], v[112:113]
    v_pk_fma_f32 v[112:113], v[46:47], v[94:95], v[112:113]
    v_pk_fma_f32 v[112:113], v[48:49], v[96:97], v[112:113]
    v_pk_fma_f32 v[112:113], v[50:51], v[98:99], v[112:113]
    v_pk_fma_f32 v[112:113], v[52:53], v[100:101], v[112:113]
    v_pk_fma_f32 v[112:113], v[54:55], v[102:103], v[112:113]
    v_add_f32 v112, v112, v113
    v_and_b32 v23, 63, v0
    v_and_b32 v24, 7, v23
    v_bfe_u32 v25, v23, 3, 2
    v_lshlrev_b32 v25, 2, v25
    v_lshl_add_u32 v25, v24, 4, v25
    v_add_u32 v25, 143104, v25
    ds_add_f32 v25, v112
    v_mul_u32_u24 v24, 528, v24
    v_lshrrev_b32 v23, 5, v23
    v_lshl_add_u32 v24, v23, 4, v24
    s_lshl_b32 s72, s37, 7
    s_add_u32 s72, s72, 121856
    v_add_u32 v24, s72, v24
    s_mov_b32 exec_lo, 0xff
    s_mov_b32 exec_hi, 0xff
    ds_add_f32 v24, v40 offset:4224
    ds_add_f32 v24, v41 offset:4228
    ds_add_f32 v24, v42 offset:4232
    ds_add_f32 v24, v43 offset:4236
    ds_add_f32 v24, v44 offset:4256
    ds_add_f32 v24, v45 offset:4260
    ds_add_f32 v24, v46 offset:4264
    ds_add_f32 v24, v47 offset:4268
    ds_add_f32 v24, v48 offset:4288
    ds_add_f32 v24, v49 offset:4292
    ds_add_f32 v24, v50 offset:4296
    ds_add_f32 v24, v51 offset:4300
    ds_add_f32 v24, v52 offset:4320
    ds_add_f32 v24, v53 offset:4324
    ds_add_f32 v24, v54 offset:4328
    ds_add_f32 v24, v55 offset:4332
    s_mov_b64 exec, -1
    s_branch K2_g1_done
K2_g2_sflush:
    s_waitcnt lgkmcnt(0)
    s_nop 7
    v_pk_mul_f32 v[112:113], v[40:41], v[88:89]
    v_pk_fma_f32 v[112:113], v[42:43], v[90:91], v[112:113]
    v_pk_fma_f32 v[112:113], v[44:45], v[92:93], v[112:113]
    v_pk_fma_f32 v[112:113], v[46:47], v[94:95], v[112:113]
    v_pk_fma_f32 v[112:113], v[48:49], v[96:97], v[112:113]
    v_pk_fma_f32 v[112:113], v[50:51], v[98:99], v[112:113]
    v_pk_fma_f32 v[112:113], v[52:53], v[100:101], v[112:113]
    v_pk_fma_f32 v[112:113], v[54:55], v[102:103], v[112:113]
    v_add_f32 v112, v112, v113
    v_and_b32 v23, 63, v0
    v_and_b32 v24, 7, v23
    v_bfe_u32 v25, v23, 3, 2
    v_lshlrev_b32 v25, 2, v25
    v_lshl_add_u32 v25, v24, 4, v25
    v_add_u32 v25, 143232, v25
    ds_add_f32 v25, v112
    v_mul_u32_u24 v24, 528, v24
    v_lshrrev_b32 v23, 5, v23
    v_lshl_add_u32 v24, v23, 4, v24
    s_lshl_b32 s72, s37, 7
    s_add_u32 s72, s72, 121856
    v_add_u32 v24, s72, v24
    s_mov_b32 exec_lo, 0xff
    s_mov_b32 exec_hi, 0xff
    ds_add_f32 v24, v40 offset:8448
    ds_add_f32 v24, v41 offset:8452
    ds_add_f32 v24, v42 offset:8456
    ds_add_f32 v24, v43 offset:8460
    ds_add_f32 v24, v44 offset:8480
    ds_add_f32 v24, v45 offset:8484
    ds_add_f32 v24, v46 offset:8488
    ds_add_f32 v24, v47 offset:8492
    ds_add_f32 v24, v48 offset:8512
    ds_add_f32 v24, v49 offset:8516
    ds_add_f32 v24, v50 offset:8520
    ds_add_f32 v24, v51 offset:8524
    ds_add_f32 v24, v52 offset:8544
    ds_add_f32 v24, v53 offset:8548
    ds_add_f32 v24, v54 offset:8552
    ds_add_f32 v24, v55 offset:8556
    s_mov_b64 exec, -1
    s_branch K2_g2_done
K2_g3_sflush:
    s_waitcnt lgkmcnt(0)
    s_nop 7
    v_pk_mul_f32 v[112:113], v[40:41], v[88:89]
    v_pk_fma_f32 v[112:113], v[42:43], v[90:91], v[112:113]
    v_pk_fma_f32 v[112:113], v[44:45], v[92:93], v[112:113]
    v_pk_fma_f32 v[112:113], v[46:47], v[94:95], v[112:113]
    v_pk_fma_f32 v[112:113], v[48:49], v[96:97], v[112:113]
    v_pk_fma_f32 v[112:113], v[50:51], v[98:99], v[112:113]
    v_pk_fma_f32 v[112:113], v[52:53], v[100:101], v[112:113]
    v_pk_fma_f32 v[112:113], v[54:55], v[102:103], v[112:113]
    v_add_f32 v112, v112, v113
    v_and_b32 v23, 63, v0
    v_and_b32 v24, 7, v23
    v_bfe_u32 v25, v23, 3, 2
    v_lshlrev_b32 v25, 2, v25
    v_lshl_add_u32 v25, v24, 4, v25
    v_add_u32 v25, 143360, v25
    ds_add_f32 v25, v112
    v_mul_u32_u24 v24, 528, v24
    v_lshrrev_b32 v23, 5, v23
    v_lshl_add_u32 v24, v23, 4, v24
    s_lshl_b32 s72, s37, 7
    s_add_u32 s72, s72, 121856
    v_add_u32 v24, s72, v24
    s_mov_b32 exec_lo, 0xff
    s_mov_b32 exec_hi, 0xff
    ds_add_f32 v24, v40 offset:12672
    ds_add_f32 v24, v41 offset:12676
    ds_add_f32 v24, v42 offset:12680
    ds_add_f32 v24, v43 offset:12684
    ds_add_f32 v24, v44 offset:12704
    ds_add_f32 v24, v45 offset:12708
    ds_add_f32 v24, v46 offset:12712
    ds_add_f32 v24, v47 offset:12716
    ds_add_f32 v24, v48 offset:12736
    ds_add_f32 v24, v49 offset:12740
    ds_add_f32 v24, v50 offset:12744
    ds_add_f32 v24, v51 offset:12748
    ds_add_f32 v24, v52 offset:12768
    ds_add_f32 v24, v53 offset:12772
    ds_add_f32 v24, v54 offset:12776
    ds_add_f32 v24, v55 offset:12780
    s_mov_b64 exec, -1
    s_branch K2_g3_done
K2_g4_sflush:
    s_waitcnt lgkmcnt(0)
    s_nop 7
    v_pk_mul_f32 v[112:113], v[40:41], v[88:89]
    v_pk_fma_f32 v[112:113], v[42:43], v[90:91], v[112:113]
    v_pk_fma_f32 v[112:113], v[44:45], v[92:93], v[112:113]
    v_pk_fma_f32 v[112:113], v[46:47], v[94:95], v[112:113]
    v_pk_fma_f32 v[112:113], v[48:49], v[96:97], v[112:113]
    v_pk_fma_f32 v[112:113], v[50:51], v[98:99], v[112:113]
    v_pk_fma_f32 v[112:113], v[52:53], v[100:101], v[112:113]
    v_pk_fma_f32 v[112:113], v[54:55], v[102:103], v[112:113]
    v_add_f32 v112, v112, v113
    v_and_b32 v23, 63, v0
    v_and_b32 v24, 7, v23
    v_bfe_u32 v25, v23, 3, 2
    v_lshlrev_b32 v25, 2, v25
    v_lshl_add_u32 v25, v24, 4, v25
    v_add_u32 v25, 143488, v25
    ds_add_f32 v25, v112
    v_mul_u32_u24 v24, 528, v24
    v_lshrrev_b32 v23, 5, v23
    v_lshl_add_u32 v24, v23, 4, v24
    s_lshl_b32 s72, s37, 7
    s_add_u32 s72, s72, 121856
    v_add_u32 v24, s72, v24
    s_mov_b32 exec_lo, 0xff
    s_mov_b32 exec_hi, 0xff
    ds_add_f32 v24, v40 offset:16896
    ds_add_f32 v24, v41 offset:16900
    ds_add_f32 v24, v42 offset:16904
    ds_add_f32 v24, v43 offset:16908
    ds_add_f32 v24, v44 offset:16928
    ds_add_f32 v24, v45 offset:16932
    ds_add_f32 v24, v46 offset:16936
    ds_add_f32 v24, v47 offset:16940
    ds_add_f32 v24, v48 offset:16960
    ds_add_f32 v24, v49 offset:16964
    ds_add_f32 v24, v50 offset:16968
    ds_add_f32 v24, v51 offset:16972
    ds_add_f32 v24, v52 offset:16992
    ds_add_f32 v24, v53 offset:16996
    ds_add_f32 v24, v54 offset:17000
    ds_add_f32 v24, v55 offset:17004
    s_mov_b64 exec, -1
    s_branch K2_g4_done
K2_slowend:
    s_waitcnt vmcnt(0) lgkmcnt(0)
    s_barrier
    v_lshrrev_b32 v8, 4, v0
    v_min_u32 v8, 39, v8
    v_and_b32 v9, 15, v0
    v_mul_u32_u24 v10, 528, v8
    v_lshl_add_u32 v10, v9, 5, v10
    v_add_u32 v10, 121856, v10
    ds_read_b128 v[24:27], v10
    ds_read_b128 v[28:31], v10 offset:16
    v_subrev_u32 v7, 640, v0
    v_mul_u32_u24 v11, 43691, v7
    v_lshrrev_b32 v11, 17, v11
    v_min_u32 v11, 39, v11
    v_add_u32 v12, v11, v7
    v_and_b32 v12, 0xff, v12
    v_lshlrev_b32 v12, 2, v12
    v_add_u32 v12, 142980, v12
    ds_read_b32 v32, v12
    s_waitcnt lgkmcnt(0)
    s_barrier
    v_cmp_gt_u32 vcc, 640, v0
    s_nop 0
    s_and_saveexec_b64 s[76:77], vcc
    s_cbranch_execz K2_se1
    v_cvt_pk_bf16_f32 v24, v24, v25
    v_cvt_pk_bf16_f32 v25, v26, v27
    v_cvt_pk_bf16_f32 v26, v28, v29
    v_cvt_pk_bf16_f32 v27, v30, v31
    v_mul_u32_u24 v10, 272, v8
    v_lshl_add_u32 v10, v9, 4, v10
    v_add_u32 v10, 121856, v10
    ds_write_b128 v10, v[24:27]
K2_se1:
    s_mov_b64 exec, s[76:77]
    v_cmp_gt_u32 vcc, 120, v7
    s_nop 0
    s_and_saveexec_b64 s[76:77], vcc
    s_cbranch_execz K2_se2
    v_mul_u32_u24 v13, 3, v11
    v_sub_u32 v13, v7, v13
    v_add_u32 v13, 1, v13
    v_and_b32 v14, 7, v11
    v_lshl_add_u32 v13, v13, 3, v14
    v_lshlrev_b32 v13, 5, v13
    v_lshrrev_b32 v14, 3, v11
    v_lshl_add_u32 v13, v14, 10, v13
    v_add_u32 v13, 139264, v13
    v_mov_b32 v33, 0
    v_mov_b32 v34, 0
    v_mov_b32 v35, 0
    v_mov_b32 v36, 0
    v_mov_b32 v37, 0
    v_mov_b32 v38, 0
    v_mov_b32 v39, 0
    ds_write_b128 v13, v[32:35]
    ds_write_b128 v13, v[36:39] offset:16
K2_se2:
    s_mov_b64 exec, s[76:77]
    v_cmp_gt_u32 vcc, 12, v0
    s_nop 0
    s_and_saveexec_b64 s[76:77], vcc
    s_cbranch_execz K2_se3
    v_add_u32 v13, 1, v0
    v_cmp_gt_u32 vcc, 5, v0
    s_nop 1
    v_cndmask_b32 v13, 0, v13, vcc
    v_lshlrev_b32 v14, 2, v0
    ds_write_b32 v14, v13 offset:32
K2_se3:
    s_mov_b64 exec, s[76:77]
    s_branch K2_epi
.section .rodata,"a"
.p2align 6
.amdhsa_kernel egnn_prep_kernel
  .amdhsa_next_free_vgpr 112
  .amdhsa_next_free_sgpr 80
  .amdhsa_accum_offset 112
  .amdhsa_group_segment_fixed_size 0
  .amdhsa_kernarg_size 88
  .amdhsa_user_sgpr_count 2
  .amdhsa_user_sgpr_kernarg_segment_ptr 1
  .amdhsa_system_sgpr_workgroup_id_x 1
.end_amdhsa_kernel
.p2align 6
.amdhsa_kernel standalone__cheap_equivariant_egnn__graph_kernel
  .amdhsa_next_free_vgpr 128
  .amdhsa_next_free_sgpr 102
  .amdhsa_accum_offset 128
  .amdhsa_group_segment_fixed_size 0
  .amdhsa_kernarg_size 88
  .amdhsa_user_sgpr_count 2
  .amdhsa_user_sgpr_kernarg_segment_ptr 1
  .amdhsa_system_sgpr_workgroup_id_x 1
.end_amdhsa_kernel
```
